```python
import torch

def _softmax(x, axis=-1):
    return torch.softmax(x, dim=axis)
def _gelu(x):
    return torch.nn.functional.gelu(x, approximate="tanh")
def _silu(x):
    return torch.nn.functional.silu(x)
def _sigmoid(x):
    return torch.sigmoid(x)
def _layernorm(x, axis=-1, eps=1e-5):
    m = x.mean(dim=axis, keepdim=True)
    v = x.var(dim=axis, keepdim=True, unbiased=False)
    return (x - m) / torch.sqrt(v + eps)
def _scatter_add(tgt, idx, src, axis=0):
    return tgt.clone().index_add_(axis, idx, src)
def _segment_sum(src, seg, n):
    out = torch.zeros((n,) + src.shape[1:], dtype=src.dtype)
    return out.index_add_(0, seg, src)
def _pad(x, pw):
    flat = tuple(v for pair in reversed(pw) for v in pair)
    return torch.nn.functional.pad(x, flat)

kernel_name = 'gated_mix__spectral_gfnet__spectral_gfnet__prompt'

def setup_inputs():

    _w = (lambda a: (lambda t: t.to(torch.bfloat16) if t.is_floating_point() else t)(torch.as_tensor(a)))
    def _A_setup():
        B, S, D = 1, 2048, 1024
        Df = D // 2 + 1
        return {
            "x": _w((lambda *s: torch.randn(*s, dtype=torch.bfloat16) * 0.05)(B, S, D)),
            "w_r": _w((lambda *s: torch.randn(*s, dtype=torch.bfloat16) * 0.05)(S, Df) * 0.02),
            "w_i": _w((lambda *s: torch.randn(*s, dtype=torch.bfloat16) * 0.05)(S, Df) * 0.02),
        }
    _A_in = _A_setup()

    def _B_setup():
        B, S, D = 1, 2048, 1024
        Df = D // 2 + 1
        return {
            "x": _w((lambda *s: torch.randn(*s, dtype=torch.bfloat16) * 0.05)(B, S, D)),
            "w_r": _w((lambda *s: torch.randn(*s, dtype=torch.bfloat16) * 0.05)(S, Df) * 0.02),
            "w_i": _w((lambda *s: torch.randn(*s, dtype=torch.bfloat16) * 0.05)(S, Df) * 0.02),
        }
    _B_in = _B_setup()

    return {
        "A_x": _A_in["x"],
        "A_w_r": _A_in["w_r"],
        "A_w_i": _A_in["w_i"],
        "B_x": _B_in["x"],
        "B_w_r": _B_in["w_r"],
        "B_w_i": _B_in["w_i"],
        "gate_w": _w((lambda *s: torch.randn(*s, dtype=torch.bfloat16) * 0.05)(1024) * 16.0),
    }

def reference(A_x, A_w_r, A_w_i, B_x, B_w_r, B_w_i, gate_w):
    def _A_ref(x, w_r, w_i):
        B, S, D = x.shape
        X = (lambda x, axes=(-2,-1): torch.fft.rfft2(x.float(), dim=axes))(x, axes=(-2, -1))
        W = w_r + 1j * w_i
        X = X * W
        y = (lambda x, s, axes=(-2,-1): torch.fft.irfft2(x, s=s, dim=axes).to(torch.bfloat16))(X, (S, D), axes=(-2, -1))
        return y

    def _B_ref(x, w_r, w_i):
        B, S, D = x.shape
        X = (lambda x, axes=(-2,-1): torch.fft.rfft2(x.float(), dim=axes))(x, axes=(-2, -1))
        W = w_r + 1j * w_i
        X = X * W
        y = (lambda x, s, axes=(-2,-1): torch.fft.irfft2(x, s=s, dim=axes).to(torch.bfloat16))(X, (S, D), axes=(-2, -1))
        return y

    x = A_x
    g = _sigmoid((x * gate_w).sum(-1, keepdims=True))
    a = _A_ref(x, A_w_r, A_w_i)
    b = _B_ref(x, B_w_r, B_w_i)
    return g * a + (1 - g) * b
```

```asm
; @launch grid=(256,1,1) block=(512,1,1) lds=70032
.amdgcn_target "amdgcn-amd-amdhsa--gfx950"
.text
.globl gated_mix__spectral_gfnet__spectral_gfnet__prompt_kernel
.p2align 8
.type gated_mix__spectral_gfnet__spectral_gfnet__prompt_kernel,@function
gated_mix__spectral_gfnet__spectral_gfnet__prompt_kernel:
L_code_start:
    s_cmp_ge_u32 s2, 256
    s_cbranch_scc1 L_end
    s_load_dwordx4 s[4:7], s[0:1], 0
    s_load_dwordx2 s[20:21], s[0:1], 72
    s_load_dwordx2 s[28:29], s[0:1], 16
    s_load_dwordx8 s[88:95], s[0:1], 32
    s_getpc_b64 s[12:13]
    s_and_b32 s12, s12, 0xffffff00
    s_mov_b32 s14, L_code_end-L_code_start
    s_mov_b32 s15, 0x00020000
    v_lshlrev_b32 v6, 6, v0
    s_bfe_u32 s8, s2, 0x30003
    v_lshrrev_b32 v1, 6, v0
    v_cmp_eq_u32 vcc, s8, v1
    s_and_saveexec_b64 s[10:11], vcc
    s_cbranch_execz L_cp
    buffer_load_ubyte v5, v6, s[12:15], 0 offen
L_cp:
    s_mov_b64 exec, -1
    v_and_b32 v0, 63, v0
    v_readfirstlane_b32 s3, v1
    v_lshlrev_b32 v2, 4, v0
    v_and_b32 v3, 31, v0
    v_lshrrev_b32 v4, 5, v0
    s_and_b32 s51, s3, 3
    s_lshl_b32 s22, s51, 9
    s_add_u32 s22, s22, s2
    s_lshl_b32 s22, s22, 11
    s_and_b32 s53, s2, 7
    s_lshl_b32 s53, s53, 5
    s_lshr_b32 s54, s2, 3
    s_add_u32 s53, s53, s54
    s_and_b32 s55, s2, 7
    s_mul_i32 s55, s55, 1026
    s_lshl_b32 s56, s54, 5
    s_add_u32 s55, s55, s56
    s_lshl_b32 s24, s51, 12
    s_lshl_b32 s57, s2, 10
    s_add_u32 s57, s57, 0x00e20000
    s_mov_b32 s26, 0x00ef0000
    v_mov_b32 v7, 0
    s_add_u32 s30, s22, 0x80000
    s_cmp_ge_u32 s3, 4
    s_cselect_b32 s31, 0, -1
    s_mov_b32 m0, s24
    s_mov_b32 s10, 0x00400000
    s_mov_b32 s11, 0x00020000
    s_mov_b32 exec_lo, s31
    s_mov_b32 exec_hi, s31
    s_waitcnt lgkmcnt(0)
    s_mov_b32 s8, s4
    s_mov_b32 s9, s5
    s_cbranch_scc1 L_nox
    buffer_load_dwordx4 v2, s[8:11], s22 offen lds
    buffer_load_dwordx4 v2, s[8:11], s22 offen offset:1024 lds
    s_add_u32 m0, s24, 2048
    s_nop 0
    buffer_load_dwordx4 v2, s[8:11], s30 offen lds
    buffer_load_dwordx4 v2, s[8:11], s30 offen offset:1024 lds
L_nox:
    s_mov_b64 exec, -1
    s_mov_b32 s16, s20
    s_mov_b32 s17, s21
    s_mov_b32 s18, 0x00f00000
    s_mov_b32 s19, 0x00020000
    buffer_load_dword v5, v7, s[16:19], s26 offen sc1
    s_mov_b32 s32, s6
    s_mov_b32 s33, s7
    s_mov_b32 s34, 0x00201000
    s_mov_b32 s35, 0x00020000
    s_mov_b32 s36, s28
    s_mov_b32 s37, s29
    s_mov_b32 s38, 0x00201000
    s_mov_b32 s39, 0x00020000
    s_mov_b32 s40, s88
    s_mov_b32 s41, s89
    s_mov_b32 s42, 0x00201000
    s_mov_b32 s43, 0x00020000
    s_mov_b32 s44, s90
    s_mov_b32 s45, s91
    s_mov_b32 s46, 0x00201000
    s_mov_b32 s47, 0x00020000
    s_mov_b32 s56, 8208
    s_cmp_ge_u32 s3, 4
    s_cbranch_scc1 L_h
    s_setprio 2
    s_cmp_eq_u32 s51, 0
    s_cselect_b32 s12, s32, s36
    s_cselect_b32 s13, s33, s37
    s_cmp_eq_u32 s51, 2
    s_cselect_b32 s12, s40, s12
    s_cselect_b32 s13, s41, s13
    s_cmp_eq_u32 s51, 3
    s_cselect_b32 s12, s44, s12
    s_cselect_b32 s13, s45, s13
    s_mov_b32 s14, 0x00201000
    s_mov_b32 s15, 0x00020000
    v_and_b32 v16, 7, v0
    s_lshl_b32 s30, s2, 3
    v_add_u32 v16, s30, v16
    v_bfe_i32 v17, v0, 4, 1
    v_xor_b32 v16, v16, v17
    v_sub_u32 v16, v16, v17
    v_and_b32 v16, 2047, v16
    v_mul_u32_u24 v18, 1026, v16
    v_bfe_u32 v17, v0, 3, 1
    v_lshl_add_u32 v18, v17, 10, v18
    buffer_load_ushort v11, v18, s[12:15], 0 offen
    s_and_b32 s30, s2, 7
    s_lshl_b32 s31, s54, 6
    s_add_u32 s30, s30, s31
    s_mul_i32 s30, s30, 1026
    v_lshrrev_b32 v16, 3, v0
    v_mul_u32_u24 v18, 8208, v16
    v_and_b32 v17, 7, v0
    v_lshl_add_u32 v10, v17, 7, v18
    v_and_b32 v17, 1, v0
    v_lshl_add_u32 v22, v17, 4, v18
    v_and_b32 v16, 7, v0
    v_bfe_u32 v17, v0, 3, 2
    v_lshl_or_b32 v8, v16, 2, v17
    v_cvt_f32_u32 v6, v8
    v_cvt_f32_u32 v7, v4
    v_mul_f32 v6, 0x3d000000, v6
    v_mul_f32 v7, 4.0, v7
    v_mul_f32 v7, v6, v7
    v_mov_b32 v16, v7
    v_fmamk_f32 v17, v6, 0x3f800000, v7
    v_cos_f32 v18, v16
    v_cos_f32 v19, v17
    v_sin_f32 v20, v16
    v_sin_f32 v21, v17
    v_mul_f32 v16, 0x3d000000, v16
    v_mul_f32 v17, 0x3d000000, v17
    v_cvt_pk_bf16_f32 v24, v18, v19
    v_cvt_pk_bf16_f32 v32, v20, v21
    v_cvt_pk_bf16_f32 v40, -v20, -v21
    v_cos_f32 v64, v16
    v_cos_f32 v65, v17
    v_sin_f32 v88, v16
    v_sin_f32 v89, v17
    v_fmamk_f32 v16, v6, 0x40000000, v7
    v_fmamk_f32 v17, v6, 0x40400000, v7
    v_cos_f32 v18, v16
    v_cos_f32 v19, v17
    v_sin_f32 v20, v16
    v_sin_f32 v21, v17
    v_mul_f32 v16, 0x3d000000, v16
    v_mul_f32 v17, 0x3d000000, v17
    v_cvt_pk_bf16_f32 v25, v18, v19
    v_cvt_pk_bf16_f32 v33, v20, v21
    v_cvt_pk_bf16_f32 v41, -v20, -v21
    v_cos_f32 v66, v16
    v_cos_f32 v67, v17
    v_sin_f32 v90, v16
    v_sin_f32 v91, v17
    v_fmamk_f32 v16, v6, 0x41000000, v7
    v_fmamk_f32 v17, v6, 0x41100000, v7
    v_cos_f32 v18, v16
    v_cos_f32 v19, v17
    v_sin_f32 v20, v16
    v_sin_f32 v21, v17
    v_mul_f32 v16, 0x3d000000, v16
    v_mul_f32 v17, 0x3d000000, v17
    v_cvt_pk_bf16_f32 v26, v18, v19
    v_cvt_pk_bf16_f32 v34, v20, v21
    v_cvt_pk_bf16_f32 v42, -v20, -v21
    v_cos_f32 v68, v16
    v_cos_f32 v69, v17
    v_sin_f32 v92, v16
    v_sin_f32 v93, v17
    v_fmamk_f32 v16, v6, 0x41200000, v7
    v_fmamk_f32 v17, v6, 0x41300000, v7
    v_cos_f32 v18, v16
    v_cos_f32 v19, v17
    v_sin_f32 v20, v16
    v_sin_f32 v21, v17
    v_mul_f32 v16, 0x3d000000, v16
    v_mul_f32 v17, 0x3d000000, v17
    v_cvt_pk_bf16_f32 v27, v18, v19
    v_cvt_pk_bf16_f32 v35, v20, v21
    v_cvt_pk_bf16_f32 v43, -v20, -v21
    v_cos_f32 v70, v16
    v_cos_f32 v71, v17
    v_sin_f32 v94, v16
    v_sin_f32 v95, v17
    v_fmamk_f32 v16, v6, 0x41800000, v7
    v_fmamk_f32 v17, v6, 0x41880000, v7
    v_cos_f32 v18, v16
    v_cos_f32 v19, v17
    v_sin_f32 v20, v16
    v_sin_f32 v21, v17
    v_mul_f32 v16, 0x3d000000, v16
    v_mul_f32 v17, 0x3d000000, v17
    v_cvt_pk_bf16_f32 v28, v18, v19
    v_cvt_pk_bf16_f32 v36, v20, v21
    v_cvt_pk_bf16_f32 v44, -v20, -v21
    v_cos_f32 v112, v16
    v_cos_f32 v113, v17
    v_sin_f32 v120, v16
    v_sin_f32 v121, v17
    v_fmamk_f32 v16, v6, 0x41900000, v7
    v_fmamk_f32 v17, v6, 0x41980000, v7
    v_cos_f32 v18, v16
    v_cos_f32 v19, v17
    v_sin_f32 v20, v16
    v_sin_f32 v21, v17
    v_mul_f32 v16, 0x3d000000, v16
    v_mul_f32 v17, 0x3d000000, v17
    v_cvt_pk_bf16_f32 v29, v18, v19
    v_cvt_pk_bf16_f32 v37, v20, v21
    v_cvt_pk_bf16_f32 v45, -v20, -v21
    v_cos_f32 v114, v16
    v_cos_f32 v115, v17
    v_sin_f32 v122, v16
    v_sin_f32 v123, v17
    v_fmamk_f32 v16, v6, 0x41c00000, v7
    v_fmamk_f32 v17, v6, 0x41c80000, v7
    v_cos_f32 v18, v16
    v_cos_f32 v19, v17
    v_sin_f32 v20, v16
    v_sin_f32 v21, v17
    v_mul_f32 v16, 0x3d000000, v16
    v_mul_f32 v17, 0x3d000000, v17
    v_cvt_pk_bf16_f32 v30, v18, v19
    v_cvt_pk_bf16_f32 v38, v20, v21
    v_cvt_pk_bf16_f32 v46, -v20, -v21
    v_cos_f32 v116, v16
    v_cos_f32 v117, v17
    v_sin_f32 v124, v16
    v_sin_f32 v125, v17
    v_fmamk_f32 v16, v6, 0x41d00000, v7
    v_fmamk_f32 v17, v6, 0x41d80000, v7
    v_cos_f32 v18, v16
    v_cos_f32 v19, v17
    v_sin_f32 v20, v16
    v_sin_f32 v21, v17
    v_mul_f32 v16, 0x3d000000, v16
    v_mul_f32 v17, 0x3d000000, v17
    v_cvt_pk_bf16_f32 v31, v18, v19
    v_cvt_pk_bf16_f32 v39, v20, v21
    v_cvt_pk_bf16_f32 v47, -v20, -v21
    v_cos_f32 v118, v16
    v_cos_f32 v119, v17
    v_sin_f32 v126, v16
    v_sin_f32 v127, v17
    buffer_load_ubyte v1, v10, s[12:15], s30 offen
    buffer_load_ubyte v1, v22, s[12:15], s30 offen offset:1024
    v_lshlrev_b32 v9, 8, v4
    v_bfe_u32 v16, v0, 2, 2
    v_lshl_or_b32 v9, v16, 6, v9
    v_bfe_u32 v16, v0, 4, 1
    v_lshl_or_b32 v9, v16, 5, v9
    v_and_b32 v16, 3, v0
    v_lshl_or_b32 v9, v16, 3, v9
    v_add_u32 v9, s24, v9
    v_and_b32 v16, 7, v0
    v_bfe_u32 v17, v0, 3, 2
    v_lshlrev_b32 v17, 1, v17
    v_xor_b32 v16, v16, v17
    v_xor_b32 v16, v16, v4
    v_lshlrev_b32 v16, 4, v16
    v_lshl_or_b32 v12, v8, 7, v16
    s_add_u32 s26, s24, 16384
    v_add_u32 v12, s26, v12
    v_xor_b32 v13, 32, v12
    v_xor_b32 v14, 64, v12
    v_xor_b32 v15, 96, v12
    v_and_b32 v16, 7, v0
    v_and_b32 v17, 16, v0
    v_lshl_or_b32 v16, v16, 1, v17
    v_bfe_u32 v17, v0, 3, 1
    v_lshl_or_b32 v16, v17, 7, v16
    s_lshl_b32 s30, s51, 5
    s_add_u32 s30, s30, 65664
    v_add_u32 v6, s30, v16
    s_waitcnt vmcnt(3)
    v_readfirstlane_b32 s48, v5
    s_mul_i32 s48, s48, 0x9E3779B1
    s_add_u32 s48, s48, 0x7F4A7C15
    s_xor_b32 s49, s48, 0x5bd1e995
    ds_read_b64_tr_b16 v[48:49], v9 offset:0
    ds_read_b64_tr_b16 v[50:51], v9 offset:512
    ds_read_b64_tr_b16 v[56:57], v9 offset:2048
    ds_read_b64_tr_b16 v[58:59], v9 offset:2560
    ds_read_b64_tr_b16 v[52:53], v9 offset:1024
    ds_read_b64_tr_b16 v[54:55], v9 offset:1536
    ds_read_b64_tr_b16 v[60:61], v9 offset:3072
    ds_read_b64_tr_b16 v[62:63], v9 offset:3584
    s_waitcnt lgkmcnt(4)
    v_mfma_f32_32x32x16_bf16 v[72:87], v[48:51], v[24:27], 0
    v_mfma_f32_32x32x16_bf16 v[96:111], v[56:59], v[24:27], 0
    v_mfma_f32_32x32x16_bf16 v[72:87], v[56:59], v[32:35], v[72:87]
    v_mfma_f32_32x32x16_bf16 v[96:111], v[48:51], v[40:43], v[96:111]
    s_waitcnt lgkmcnt(0)
    v_mfma_f32_32x32x16_bf16 v[72:87], v[52:55], v[28:31], v[72:87]
    v_mfma_f32_32x32x16_bf16 v[96:111], v[60:63], v[28:31], v[96:111]
    v_mfma_f32_32x32x16_bf16 v[72:87], v[60:63], v[36:39], v[72:87]
    v_mfma_f32_32x32x16_bf16 v[96:111], v[52:55], v[44:47], v[96:111]
    s_nop 10
    v_mul_f32 v16, v72, v64
    v_mul_f32 v18, v96, v64
    v_fmac_f32 v16, v96, v88
    v_fma_f32 v18, -v72, v88, v18
    v_mul_f32 v17, v73, v65
    v_mul_f32 v19, v97, v65
    v_fmac_f32 v17, v97, v89
    v_fma_f32 v19, -v73, v89, v19
    v_cvt_pk_bf16_f32 v48, v16, v17
    v_cvt_pk_bf16_f32 v56, v18, v19
    v_mul_f32 v16, v74, v66
    v_mul_f32 v18, v98, v66
    v_fmac_f32 v16, v98, v90
    v_fma_f32 v18, -v74, v90, v18
    v_mul_f32 v17, v75, v67
    v_mul_f32 v19, v99, v67
    v_fmac_f32 v17, v99, v91
    v_fma_f32 v19, -v75, v91, v19
    v_cvt_pk_bf16_f32 v49, v16, v17
    v_cvt_pk_bf16_f32 v57, v18, v19
    v_mul_f32 v16, v76, v68
    v_mul_f32 v18, v100, v68
    v_fmac_f32 v16, v100, v92
    v_fma_f32 v18, -v76, v92, v18
    v_mul_f32 v17, v77, v69
    v_mul_f32 v19, v101, v69
    v_fmac_f32 v17, v101, v93
    v_fma_f32 v19, -v77, v93, v19
    v_cvt_pk_bf16_f32 v50, v16, v17
    v_cvt_pk_bf16_f32 v58, v18, v19
    v_mul_f32 v16, v78, v70
    v_mul_f32 v18, v102, v70
    v_fmac_f32 v16, v102, v94
    v_fma_f32 v18, -v78, v94, v18
    v_mul_f32 v17, v79, v71
    v_mul_f32 v19, v103, v71
    v_fmac_f32 v17, v103, v95
    v_fma_f32 v19, -v79, v95, v19
    v_cvt_pk_bf16_f32 v51, v16, v17
    v_cvt_pk_bf16_f32 v59, v18, v19
    s_nop 0
    v_mfma_f32_32x32x16_bf16 v[64:79], v[48:51], v[24:27], 0
    v_mul_f32 v16, v80, v112
    v_mul_f32 v18, v104, v112
    v_fmac_f32 v16, v104, v120
    v_fma_f32 v18, -v80, v120, v18
    v_mul_f32 v17, v81, v113
    v_mul_f32 v19, v105, v113
    v_fmac_f32 v17, v105, v121
    v_fma_f32 v19, -v81, v121, v19
    v_cvt_pk_bf16_f32 v52, v16, v17
    v_cvt_pk_bf16_f32 v60, v18, v19
    v_mfma_f32_32x32x16_bf16 v[88:103], v[56:59], v[24:27], 0
    v_mul_f32 v16, v82, v114
    v_mul_f32 v18, v106, v114
    v_fmac_f32 v16, v106, v122
    v_fma_f32 v18, -v82, v122, v18
    v_mul_f32 v17, v83, v115
    v_mul_f32 v19, v107, v115
    v_fmac_f32 v17, v107, v123
    v_fma_f32 v19, -v83, v123, v19
    v_cvt_pk_bf16_f32 v53, v16, v17
    v_cvt_pk_bf16_f32 v61, v18, v19
    v_mfma_f32_32x32x16_bf16 v[64:79], v[56:59], v[32:35], v[64:79]
    v_mul_f32 v16, v84, v116
    v_mul_f32 v18, v108, v116
    v_fmac_f32 v16, v108, v124
    v_fma_f32 v18, -v84, v124, v18
    v_mul_f32 v17, v85, v117
    v_mul_f32 v19, v109, v117
    v_fmac_f32 v17, v109, v125
    v_fma_f32 v19, -v85, v125, v19
    v_cvt_pk_bf16_f32 v54, v16, v17
    v_cvt_pk_bf16_f32 v62, v18, v19
    v_mfma_f32_32x32x16_bf16 v[88:103], v[48:51], v[40:43], v[88:103]
    v_mul_f32 v16, v86, v118
    v_mul_f32 v18, v110, v118
    v_fmac_f32 v16, v110, v126
    v_fma_f32 v18, -v86, v126, v18
    v_mul_f32 v17, v87, v119
    v_mul_f32 v19, v111, v119
    v_fmac_f32 v17, v111, v127
    v_fma_f32 v19, -v87, v127, v19
    v_cvt_pk_bf16_f32 v55, v16, v17
    v_cvt_pk_bf16_f32 v63, v18, v19
    s_nop 0
    v_mfma_f32_32x32x16_bf16 v[64:79], v[52:55], v[28:31], v[64:79]
    v_mfma_f32_32x32x16_bf16 v[88:103], v[60:63], v[28:31], v[88:103]
    v_mfma_f32_32x32x16_bf16 v[64:79], v[60:63], v[36:39], v[64:79]
    v_mfma_f32_32x32x16_bf16 v[88:103], v[52:55], v[44:47], v[88:103]
    s_waitcnt vmcnt(2)
    ds_write_b16 v6, v11
    s_nop 9
    v_cvt_pk_bf16_f32 v24, v64, v88
    v_cvt_pk_bf16_f32 v25, v65, v89
    v_cvt_pk_bf16_f32 v26, v66, v90
    v_cvt_pk_bf16_f32 v27, v67, v91
    ds_write_b128 v12, v[24:27]
    v_cvt_pk_bf16_f32 v28, v68, v92
    v_cvt_pk_bf16_f32 v29, v69, v93
    v_cvt_pk_bf16_f32 v30, v70, v94
    v_cvt_pk_bf16_f32 v31, v71, v95
    ds_write_b128 v13, v[28:31]
    v_cvt_pk_bf16_f32 v32, v72, v96
    v_cvt_pk_bf16_f32 v33, v73, v97
    v_cvt_pk_bf16_f32 v34, v74, v98
    v_cvt_pk_bf16_f32 v35, v75, v99
    ds_write_b128 v14, v[32:35]
    v_cvt_pk_bf16_f32 v36, v76, v100
    v_cvt_pk_bf16_f32 v37, v77, v101
    v_cvt_pk_bf16_f32 v38, v78, v102
    v_cvt_pk_bf16_f32 v39, v79, v103
    ds_write_b128 v15, v[36:39]
    s_waitcnt lgkmcnt(0)
    s_barrier
    s_setprio 0
    v_lshrrev_b32 v5, 4, v0
    v_and_b32 v6, 15, v0
    v_lshrrev_b32 v8, 2, v0
    v_mul_u32_u24 v27, 264192, v8
    v_and_b32 v8, 3, v0
    v_lshl_add_u32 v27, v8, 4, v27
    s_lshl_b32 s27, s3, 11
    s_mul_i32 s23, s3, 6144
    s_add_u32 s23, s23, 16384
    v_bfe_u32 v8, v0, 1, 4
    v_and_b32 v9, 1, v0
    v_lshl_add_u32 v8, v8, 4, v9
    v_lshlrev_b32 v7, 10, v8
    s_lshl_b32 s28, s3, 8
    s_and_b32 s8, s2, 7
    s_lshl_b32 s8, s8, 7
    s_add_u32 s8, s8, s27
    s_add_u32 s8, s8, 0x00e20000
    v_lshlrev_b32 v8, 4, v6
    v_lshl_or_b32 v9, v5, 9, v8
    v_add_u32 v25, s27, v9
    v_add_u32 v30, s23, v9
    v_lshl_or_b32 v26, v5, 12, v8
    v_add_u32 v26, s28, v26
    v_mul_u32_u24 v31, 12288, v5
    s_add_u32 s29, s28, 16384
    v_add3_u32 v31, v31, v8, s29
    v_mul_u32_u24 v24, 1056768, v5
    v_lshl_add_u32 v24, v6, 2, v24
    s_mul_i32 s24, s3, 33024
    s_lshl_b32 s26, s53, 6
    s_add_u32 s24, s24, s26
    s_add_u32 s26, s24, 16512
    v_lshlrev_b32 v8, 2, v6
    v_lshl_or_b32 v28, v5, 8, v8
    v_add_u32 v28, s27, v28
    s_and_b32 s29, s55, 15
    s_add_u32 s29, s29, s23
    v_mul_u32_u24 v29, 192, v5
    v_lshl_add_u32 v29, v6, 1, v29
    v_add_u32 v29, s29, v29
    s_lshl_b32 s30, s53, 15
    s_add_u32 s30, s30, s28
    s_add_u32 s30, s30, 0x00500000
    s_add_u32 s31, s30, 4096
    s_lshl_b32 s9, s53, 10
    s_lshl_b32 s10, s3, 7
    s_add_u32 s9, s9, s10
    s_add_u32 s9, s9, 0x00e80000
    s_mul_i32 s50, s3, 33024
    s_and_b32 s29, s2, 7
    s_lshl_b32 s29, s29, 4
    s_add_u32 s50, s50, s29
    s_add_u32 s50, s50, 16384
    s_cmp_eq_u32 s54, 0
    s_cselect_b32 s52, 0x00010001, 0
    v_bfe_u32 v8, v0, 4, 1
    v_lshl_add_u32 v8, v6, 4, v8
    v_mul_u32_u24 v2, 16512, v8
    s_cselect_b32 s59, -1, 0
    v_mul_u32_u24 v8, 43, v0
    v_lshrrev_b32 v8, 7, v8
    v_mul_u32_u24 v9, 3, v8
    v_sub_u32 v9, v0, v9
    v_mul_u32_u24 v112, 131328, v8
    v_lshl_add_u32 v112, v9, 4, v112
    s_barrier
    v_cvt_f32_u32 v14, v6
    v_cvt_f32_u32 v15, v5
    v_mul_f32 v15, 4.0, v15
    v_cvt_f32_u32 v16, s3
    v_mul_f32 v16, 0x3c000000, v16
    v_mul_f32 v18, v14, v16
    v_fmamk_f32 v19, v14, 0x3b800000, v18
    v_mul_f32 v14, 0x3d800000, v14
    s_add_u32 s6, s3, 0
    s_mul_i32 s4, s6, 16416
    s_add_u32 s4, s4, s55
    s_and_b32 s4, s4, 0xfffffff0
    s_add_u32 s5, s4, 8208
    s_mul_i32 s6, s6, 6144
    s_mov_b32 exec_hi, 0xffff
    s_add_u32 m0, s6, 19456
    s_nop 0
    buffer_load_dwordx4 v112, s[40:43], s4 offen lds
    s_mov_b32 exec_hi, -1
    s_mov_b32 exec_hi, 0xffff
    s_add_u32 m0, s6, 20224
    s_nop 0
    buffer_load_dwordx4 v112, s[40:43], s5 offen lds
    s_mov_b32 exec_hi, -1
    v_mul_f32 v20, v15, v14
    v_cos_f32 v11, v20
    v_sin_f32 v12, v20
    v_mov_b32 v32, 0
    v_cvt_pk_bf16_f32 v72, v11, v12
    v_cvt_pk_bf16_f32 v76, -v12, v11
    s_mov_b32 exec_hi, 0xffff
    s_add_u32 m0, s6, 20992
    s_nop 0
    buffer_load_dwordx4 v112, s[44:47], s4 offen lds
    s_mov_b32 exec_hi, -1
    v_add_f32 v15, 1.0, v15
    v_mul_f32 v21, v15, v14
    v_cos_f32 v11, v21
    v_sin_f32 v12, v21
    v_mov_b32 v33, 0
    v_cvt_pk_bf16_f32 v73, v11, v12
    v_cvt_pk_bf16_f32 v77, -v12, v11
    s_mov_b32 exec_hi, 0xffff
    s_add_u32 m0, s6, 21760
    s_nop 0
    buffer_load_dwordx4 v112, s[44:47], s5 offen lds
    s_mov_b32 exec_hi, -1
    v_add_f32 v15, 1.0, v15
    v_mul_f32 v22, v15, v14
    v_cos_f32 v11, v22
    v_sin_f32 v12, v22
    v_mov_b32 v34, 0
    v_cvt_pk_bf16_f32 v74, v11, v12
    v_cvt_pk_bf16_f32 v78, -v12, v11
    s_mov_b32 exec_hi, 0xffff
    s_add_u32 m0, s6, 16384
    s_nop 0
    buffer_load_dwordx4 v112, s[32:35], s4 offen lds
    s_mov_b32 exec_hi, -1
    v_add_f32 v15, 1.0, v15
    v_mul_f32 v23, v15, v14
    v_cos_f32 v11, v23
    v_sin_f32 v12, v23
    v_mov_b32 v35, 0
    v_cvt_pk_bf16_f32 v75, v11, v12
    v_cvt_pk_bf16_f32 v79, -v12, v11
    s_mov_b32 exec_hi, 0xffff
    s_add_u32 m0, s6, 17152
    s_nop 0
    buffer_load_dwordx4 v112, s[32:35], s5 offen lds
    s_mov_b32 exec_hi, -1
    v_fma_f32 v8, v15, v16, v23
    v_fmamk_f32 v9, v15, 0x3b800000, v8
    v_cos_f32 v11, v8
    v_sin_f32 v12, v8
    v_add_f32 v10, v23, v18
    v_cvt_pk_bf16_f32 v83, v11, v12
    v_cvt_pk_bf16_f32 v87, -v12, v11
    s_mov_b32 exec_hi, 0xffff
    s_add_u32 m0, s6, 17920
    s_nop 0
    buffer_load_dwordx4 v112, s[36:39], s4 offen lds
    s_mov_b32 exec_hi, -1
    v_cos_f32 v11, v9
    v_sin_f32 v12, v9
    v_add_f32 v13, v23, v19
    v_cvt_pk_bf16_f32 v91, v11, v12
    v_cvt_pk_bf16_f32 v95, -v12, v11
    s_mov_b32 exec_hi, 0xffff
    s_add_u32 m0, s6, 18688
    s_nop 0
    buffer_load_dwordx4 v112, s[36:39], s5 offen lds
    s_mov_b32 exec_hi, -1
    v_cos_f32 v11, v10
    v_sin_f32 v12, v10
    v_subrev_f32 v15, 1.0, v15
    v_cvt_pk_bf16_f32 v99, v11, v12
    v_cvt_pk_bf16_f32 v103, -v12, v11
    s_add_u32 s6, s3, 4
    s_mul_i32 s4, s6, 16416
    s_add_u32 s4, s4, s55
    s_and_b32 s4, s4, 0xfffffff0
    s_add_u32 s5, s4, 8208
    s_mul_i32 s6, s6, 6144
    s_mov_b32 exec_hi, 0xffff
    s_add_u32 m0, s6, 19456
    s_nop 0
    buffer_load_dwordx4 v112, s[40:43], s4 offen lds
    s_mov_b32 exec_hi, -1
    v_cos_f32 v11, v13
    v_sin_f32 v12, v13
    v_mov_b32 v36, 0
    v_cvt_pk_bf16_f32 v107, v11, v12
    v_cvt_pk_bf16_f32 v111, -v12, v11
    s_mov_b32 exec_hi, 0xffff
    s_add_u32 m0, s6, 20224
    s_nop 0
    buffer_load_dwordx4 v112, s[40:43], s5 offen lds
    s_mov_b32 exec_hi, -1
    v_fma_f32 v8, v15, v16, v22
    v_fmamk_f32 v9, v15, 0x3b800000, v8
    v_cos_f32 v11, v8
    v_sin_f32 v12, v8
    v_add_f32 v10, v22, v18
    v_cvt_pk_bf16_f32 v82, v11, v12
    v_cvt_pk_bf16_f32 v86, -v12, v11
    s_mov_b32 exec_hi, 0xffff
    s_add_u32 m0, s6, 20992
    s_nop 0
    buffer_load_dwordx4 v112, s[44:47], s4 offen lds
    s_mov_b32 exec_hi, -1
    v_cos_f32 v11, v9
    v_sin_f32 v12, v9
    v_add_f32 v13, v22, v19
    v_cvt_pk_bf16_f32 v90, v11, v12
    v_cvt_pk_bf16_f32 v94, -v12, v11
    s_mov_b32 exec_hi, 0xffff
    s_add_u32 m0, s6, 21760
    s_nop 0
    buffer_load_dwordx4 v112, s[44:47], s5 offen lds
    s_mov_b32 exec_hi, -1
    v_cos_f32 v11, v10
    v_sin_f32 v12, v10
    v_subrev_f32 v15, 1.0, v15
    v_cvt_pk_bf16_f32 v98, v11, v12
    v_cvt_pk_bf16_f32 v102, -v12, v11
    s_mov_b32 exec_hi, 0xffff
    s_add_u32 m0, s6, 16384
    s_nop 0
    buffer_load_dwordx4 v112, s[32:35], s4 offen lds
    s_mov_b32 exec_hi, -1
    v_cos_f32 v11, v13
    v_sin_f32 v12, v13
    v_mov_b32 v37, 0
    v_cvt_pk_bf16_f32 v106, v11, v12
    v_cvt_pk_bf16_f32 v110, -v12, v11
    s_mov_b32 exec_hi, 0xffff
    s_add_u32 m0, s6, 17152
    s_nop 0
    buffer_load_dwordx4 v112, s[32:35], s5 offen lds
    s_mov_b32 exec_hi, -1
    v_fma_f32 v8, v15, v16, v21
    v_fmamk_f32 v9, v15, 0x3b800000, v8
    v_cos_f32 v11, v8
    v_sin_f32 v12, v8
    v_add_f32 v10, v21, v18
    v_cvt_pk_bf16_f32 v81, v11, v12
    v_cvt_pk_bf16_f32 v85, -v12, v11
    s_mov_b32 exec_hi, 0xffff
    s_add_u32 m0, s6, 17920
    s_nop 0
    buffer_load_dwordx4 v112, s[36:39], s4 offen lds
    s_mov_b32 exec_hi, -1
    v_cos_f32 v11, v9
    v_sin_f32 v12, v9
    v_add_f32 v13, v21, v19
    v_cvt_pk_bf16_f32 v89, v11, v12
    v_cvt_pk_bf16_f32 v93, -v12, v11
    s_mov_b32 exec_hi, 0xffff
    s_add_u32 m0, s6, 18688
    s_nop 0
    buffer_load_dwordx4 v112, s[36:39], s5 offen lds
    s_mov_b32 exec_hi, -1
    v_cos_f32 v11, v10
    v_sin_f32 v12, v10
    v_subrev_f32 v15, 1.0, v15
    v_cvt_pk_bf16_f32 v97, v11, v12
    v_cvt_pk_bf16_f32 v101, -v12, v11
    v_cos_f32 v11, v13
    v_sin_f32 v12, v13
    v_mov_b32 v38, 0
    v_cvt_pk_bf16_f32 v105, v11, v12
    v_cvt_pk_bf16_f32 v109, -v12, v11
    v_fma_f32 v8, v15, v16, v20
    v_fmamk_f32 v9, v15, 0x3b800000, v8
    v_cos_f32 v11, v8
    v_sin_f32 v12, v8
    v_add_f32 v10, v20, v18
    v_cvt_pk_bf16_f32 v80, v11, v12
    v_cvt_pk_bf16_f32 v84, -v12, v11
    v_cos_f32 v11, v9
    v_sin_f32 v12, v9
    v_add_f32 v13, v20, v19
    v_cvt_pk_bf16_f32 v88, v11, v12
    v_cvt_pk_bf16_f32 v92, -v12, v11
    v_cos_f32 v11, v10
    v_sin_f32 v12, v10
    v_subrev_f32 v15, 1.0, v15
    v_cvt_pk_bf16_f32 v96, v11, v12
    v_cvt_pk_bf16_f32 v100, -v12, v11
    v_cos_f32 v11, v13
    v_sin_f32 v12, v13
    v_mov_b32 v39, 0
    v_cvt_pk_bf16_f32 v104, v11, v12
    v_cvt_pk_bf16_f32 v108, -v12, v11
    v_mov_b32 v40, 0
    v_mov_b32 v41, 0
    v_mov_b32 v42, 0
    v_mov_b32 v43, 0
    v_mov_b32 v44, 0
    v_mov_b32 v45, 0
    v_mov_b32 v46, 0
    v_mov_b32 v47, 0
    v_mov_b32 v48, 0
    v_mov_b32 v49, 0
    v_mov_b32 v50, 0
    v_mov_b32 v51, 0
    v_mov_b32 v52, 0
    v_mov_b32 v53, 0
    v_mov_b32 v54, 0
    v_mov_b32 v55, 0
    v_mov_b32 v56, 0
    v_mov_b32 v57, 0
    v_mov_b32 v58, 0
    v_mov_b32 v59, 0
    v_mov_b32 v60, 0
    v_mov_b32 v61, 0
    v_mov_b32 v62, 0
    v_mov_b32 v63, 0
    v_add_f32 v16, 0x3c000000, v16
    v_mov_b32 v17, v15
    v_add_f32 v17, 1.0, v17
    v_fma_f32 v20, v17, v16, v20
    v_add_f32 v17, 1.0, v17
    v_fma_f32 v21, v17, v16, v21
    v_add_f32 v17, 1.0, v17
    v_fma_f32 v22, v17, v16, v22
    v_add_f32 v17, 1.0, v17
    v_fma_f32 v23, v17, v16, v23
    v_cos_f32 v18, v20
    v_sin_f32 v19, v20
    s_nop 0
    v_cvt_pk_bf16_f32 v8, v18, v19
    v_cvt_pk_bf16_f32 v12, -v19, v18
    v_cos_f32 v18, v21
    v_sin_f32 v19, v21
    s_nop 0
    v_cvt_pk_bf16_f32 v9, v18, v19
    v_cvt_pk_bf16_f32 v13, -v19, v18
    v_cos_f32 v18, v22
    v_sin_f32 v19, v22
    s_nop 0
    v_cvt_pk_bf16_f32 v10, v18, v19
    v_cvt_pk_bf16_f32 v14, -v19, v18
    v_cos_f32 v18, v23
    v_sin_f32 v19, v23
    s_nop 0
    v_cvt_pk_bf16_f32 v11, v18, v19
    v_cvt_pk_bf16_f32 v15, -v19, v18
    s_branch L_p2
L_h:
    s_mov_b32 s8, s92
    s_mov_b32 s9, s93
    s_mov_b32 s10, 0x00000800
    s_mov_b32 s11, 0x00020000
    buffer_load_dwordx4 v[32:35], v2, s[8:11], 0 offen
    buffer_load_dwordx4 v[36:39], v2, s[8:11], 0 offen offset:1024
    v_add_u32 v40, s24, v2
    v_mov_b32 v9, 65920
    v_mov_b32 v10, 0
    ds_write_b32 v9, v10
    v_bfe_u32 v6, v0, 3, 1
    v_bfe_u32 v7, v0, 1, 1
    v_lshl_or_b32 v6, v6, 1, v7
    v_and_or_b32 v48, v0, 4, v6
    v_cvt_f32_u32 v48, v48
    v_cvt_f32_u32 v52, v4
    v_fma_f32 v52, v52, -2.0, 1.0
    v_mul_f32 v49, v48, v52
    v_mul_f32 v49, 0x3e000000, v49
    v_and_b32 v6, 1, v0
    v_cvt_f32_u32 v6, v6
    v_mul_f32 v50, v6, v52
    v_mul_f32 v50, 0x3e800000, v50
    v_cvt_f32_u32 v7, s2
    v_mul_f32 v7, 0x3b800000, v7
    v_fmac_f32 v50, v7, v49
    v_add_f32 v51, 0x3e800000, v50
    v_mov_b32 v6, v50
    v_fmamk_f32 v7, v49, 0x3f800000, v51
    v_cos_f32 v8, v6
    v_cos_f32 v9, v7
    v_sin_f32 v10, v6
    v_sin_f32 v11, v7
    v_add_f32 v8, v8, v9
    v_add_f32 v10, v10, v11
    v_cvt_pk_bf16_f32 v44, v8, v10
    v_fmamk_f32 v6, v49, 0x40000000, v50
    v_fmamk_f32 v7, v49, 0x40400000, v51
    v_cos_f32 v8, v6
    v_cos_f32 v9, v7
    v_sin_f32 v10, v6
    v_sin_f32 v11, v7
    v_add_f32 v8, v8, v9
    v_add_f32 v10, v10, v11
    v_cvt_pk_bf16_f32 v45, v8, v10
    v_fmamk_f32 v6, v49, 0x40800000, v50
    v_fmamk_f32 v7, v49, 0x40a00000, v51
    v_cos_f32 v8, v6
    v_cos_f32 v9, v7
    v_sin_f32 v10, v6
    v_sin_f32 v11, v7
    v_add_f32 v8, v8, v9
    v_add_f32 v10, v10, v11
    v_cvt_pk_bf16_f32 v46, v8, v10
    v_fmamk_f32 v6, v49, 0x40c00000, v50
    v_fmamk_f32 v7, v49, 0x40e00000, v51
    v_cos_f32 v8, v6
    v_cos_f32 v9, v7
    v_sin_f32 v10, v6
    v_sin_f32 v11, v7
    v_add_f32 v8, v8, v9
    v_add_f32 v10, v10, v11
    v_cvt_pk_bf16_f32 v47, v8, v10
    s_lshl_b32 s30, s51, 7
    v_lshlrev_b32 v6, 2, v3
    v_sub_u32 v54, 0, v4
    v_add3_u32 v53, v6, s30, 0
    v_xor_b32 v53, v53, v54
    v_add_u32 v53, v53, v4
    v_bfe_u32 v7, v53, 5, 5
    v_bfe_u32 v8, v53, 7, 3
    v_xor_b32 v9, v53, v7
    v_and_b32 v9, 3, v9
    v_bfe_u32 v10, v53, 4, 1
    v_lshl_or_b32 v9, v9, 1, v10
    v_xor_b32 v9, v9, v8
    v_and_b32 v10, 12, v53
    v_lshl_or_b32 v10, v9, 4, v10
    v_lshl_or_b32 v96, v7, 7, v10
    v_add3_u32 v53, v6, s30, 1
    v_xor_b32 v53, v53, v54
    v_add_u32 v53, v53, v4
    v_bfe_u32 v7, v53, 5, 5
    v_bfe_u32 v8, v53, 7, 3
    v_xor_b32 v9, v53, v7
    v_and_b32 v9, 3, v9
    v_bfe_u32 v10, v53, 4, 1
    v_lshl_or_b32 v9, v9, 1, v10
    v_xor_b32 v9, v9, v8
    v_and_b32 v10, 12, v53
    v_lshl_or_b32 v10, v9, 4, v10
    v_lshl_or_b32 v97, v7, 7, v10
    v_add3_u32 v53, v6, s30, 2
    v_xor_b32 v53, v53, v54
    v_add_u32 v53, v53, v4
    v_bfe_u32 v7, v53, 5, 5
    v_bfe_u32 v8, v53, 7, 3
    v_xor_b32 v9, v53, v7
    v_and_b32 v9, 3, v9
    v_bfe_u32 v10, v53, 4, 1
    v_lshl_or_b32 v9, v9, 1, v10
    v_xor_b32 v9, v9, v8
    v_and_b32 v10, 12, v53
    v_lshl_or_b32 v10, v9, 4, v10
    v_lshl_or_b32 v98, v7, 7, v10
    v_add3_u32 v53, v6, s30, 3
    v_xor_b32 v53, v53, v54
    v_add_u32 v53, v53, v4
    v_bfe_u32 v7, v53, 5, 5
    v_bfe_u32 v8, v53, 7, 3
    v_xor_b32 v9, v53, v7
    v_and_b32 v9, 3, v9
    v_bfe_u32 v10, v53, 4, 1
    v_lshl_or_b32 v9, v9, 1, v10
    v_xor_b32 v9, v9, v8
    v_and_b32 v10, 12, v53
    v_lshl_or_b32 v10, v9, 4, v10
    v_lshl_or_b32 v99, v7, 7, v10
    v_add_u32 v53, 512, v6
    v_xor_b32 v53, v53, v54
    v_add_u32 v53, v53, v4
    v_bfe_u32 v7, v53, 5, 5
    v_bfe_u32 v8, v53, 7, 3
    v_xor_b32 v9, v53, v7
    v_and_b32 v9, 3, v9
    v_bfe_u32 v10, v53, 4, 1
    v_lshl_or_b32 v9, v9, 1, v10
    v_xor_b32 v9, v9, v8
    v_and_b32 v10, 12, v53
    v_lshl_or_b32 v10, v9, 4, v10
    v_lshl_or_b32 v100, v7, 7, v10
    v_lshlrev_b32 v6, 13, v4
    v_lshl_or_b32 v101, v3, 4, v6
    v_and_b32 v6, 7, v0
    v_bfe_u32 v7, v0, 3, 1
    v_lshlrev_b32 v8, 3, v7
    v_lshl_or_b32 v105, v6, 4, v8
    v_and_b32 v8, 3, v0
    v_cmp_eq_u32 vcc, 0, v8
    v_lshrrev_b32 v9, 2, v6
    v_cvt_f32_u32 v10, v7
    v_fma_f32 v10, v10, -2.0, 1.0
    v_cndmask_b32 v9, v9, v7, vcc
    v_cndmask_b32 v104, 0, v10, vcc
    v_lshlrev_b32 v6, 1, v6
    v_lshl_or_b32 v6, v7, 6, v6
    v_lshl_or_b32 v6, v9, 7, v6
    v_add_u32 v102, 65664, v6
    v_xor_b32 v103, 64, v102
    v_mov_b32 v106, 0
    v_mov_b32 v107, 0
    v_mov_b32 v108, 0
    v_mov_b32 v109, 0
    v_mov_b32 v110, 0
    v_mov_b32 v111, 0
    v_mov_b32 v112, 0
    v_mov_b32 v113, 0
    s_mul_i32 s8, s2, 16512
    s_lshl_b32 s9, s51, 9
    s_add_u32 s9, s9, s8
    s_add_u32 s10, s9, 4096
    s_add_u32 s8, s8, 16384
    s_mov_b32 s11, 0xffff0000
    v_mov_b32 v124, 0x3f803f80
    v_mov_b32 v116, 0
    v_mov_b32 v118, 0
    s_waitcnt lgkmcnt(0)
    s_waitcnt vmcnt(2) lgkmcnt(0)
    v_readfirstlane_b32 s48, v5
    s_mul_i32 s48, s48, 0x9E3779B1
    s_add_u32 s48, s48, 0x7F4A7C15
    s_xor_b32 s49, s48, 0x5bd1e995
    s_cmp_eq_u32 s51, 1
    s_cselect_b32 exec_lo, -1, 0
    s_cselect_b32 exec_hi, -1, 0
    v_mov_b32 v48, s49
    v_mov_b32 v49, s49
    v_mov_b32 v50, s49
    v_mov_b32 v51, s49
    buffer_store_dwordx4 v[48:51], v2, s[16:19], s57 offen sc1
    s_mov_b64 exec, -1
    s_setprio 2
    s_barrier
    ds_read2st64_b32 v[120:121], v100 offset0:64 offset1:80
    ds_read2st64_b32 v[122:123], v100 offset0:96 offset1:112
    ds_read2st64_b32 v[16:17], v96 offset0:64 offset1:80
    ds_read2st64_b32 v[18:19], v96 offset0:96 offset1:112
    ds_read2st64_b32 v[20:21], v97 offset0:64 offset1:80
    ds_read2st64_b32 v[22:23], v97 offset0:96 offset1:112
    ds_read2st64_b32 v[24:25], v98 offset0:64 offset1:80
    ds_read2st64_b32 v[26:27], v98 offset0:96 offset1:112
    ds_read2st64_b32 v[28:29], v99 offset0:64 offset1:80
    ds_read2st64_b32 v[30:31], v99 offset0:96 offset1:112
    ds_read_u16_d16_hi v106, v102 offset:0
    ds_read_u16_d16_hi v110, v103 offset:0
    ds_read_u16_d16_hi v107, v102 offset:16
    ds_read_u16_d16_hi v111, v103 offset:16
    ds_read_u16_d16_hi v108, v102 offset:32
    ds_read_u16_d16_hi v112, v103 offset:32
    ds_read_u16_d16_hi v109, v102 offset:48
    ds_read_u16_d16_hi v113, v103 offset:48
    s_waitcnt lgkmcnt(15)
    v_mfma_f32_32x32x16_bf16 v[48:63], v[44:47], v[120:123], 0
    s_waitcnt lgkmcnt(14)
    v_mfma_f32_32x32x16_bf16 v[56:71], v[44:47], v[16:19], 0
    s_waitcnt lgkmcnt(12)
    v_mfma_f32_32x32x16_bf16 v[64:79], v[44:47], v[20:23], 0
    s_waitcnt lgkmcnt(10)
    v_mfma_f32_32x32x16_bf16 v[72:87], v[44:47], v[24:27], 0
    s_waitcnt lgkmcnt(8)
    v_mfma_f32_32x32x16_bf16 v[80:95], v[44:47], v[28:31], 0
    s_waitcnt lgkmcnt(0)
    v_add_f32 v114, v106, v107
    v_sub_f32 v115, v108, v109
    v_add_f32 v110, v110, v111
    v_sub_f32 v112, v112, v113
    v_fma_f32 v114, -v104, v112, v114
    v_fmac_f32 v115, v104, v110
    s_cmp_eq_u32 s51, 1
    s_cselect_b32 exec_lo, 0xffff, 0
    s_mov_b32 exec_hi, 0
    buffer_store_dwordx2 v[114:115], v105, s[16:19], s8 offen sc1
    s_mov_b64 exec, -1
    s_cmp_eq_u32 s51, 0
    s_cselect_b32 exec_lo, 1, 0
    s_cselect_b32 exec_hi, 1, 0
    v_sub_f32 v56, v56, v49
    v_add_f32 v57, v57, v48
    s_mov_b32 exec_lo, 0
    v_mov_b32 v58, v50
    v_mov_b32 v59, v51
    v_mov_b32 v60, v52
    v_mov_b32 v61, v53
    v_mov_b32 v62, v54
    v_mov_b32 v63, v55
    s_mov_b64 exec, -1
    v_cvt_pk_bf16_f32 v16, v56, v57
    v_cvt_pk_bf16_f32 v17, v64, v65
    v_cvt_pk_bf16_f32 v18, v72, v73
    v_cvt_pk_bf16_f32 v19, v80, v81
    buffer_store_dwordx4 v[16:19], v101, s[16:19], s9 offen offset:0 sc1
    v_cvt_pk_bf16_f32 v20, v58, v59
    v_cvt_pk_bf16_f32 v21, v66, v67
    v_cvt_pk_bf16_f32 v22, v74, v75
    v_cvt_pk_bf16_f32 v23, v82, v83
    buffer_store_dwordx4 v[20:23], v101, s[16:19], s9 offen offset:2048 sc1
    v_cvt_pk_bf16_f32 v24, v60, v61
    v_cvt_pk_bf16_f32 v25, v68, v69
    v_cvt_pk_bf16_f32 v26, v76, v77
    v_cvt_pk_bf16_f32 v27, v84, v85
    buffer_store_dwordx4 v[24:27], v101, s[16:19], s10 offen offset:0 sc1
    v_cvt_pk_bf16_f32 v28, v62, v63
    v_cvt_pk_bf16_f32 v29, v70, v71
    v_cvt_pk_bf16_f32 v30, v78, v79
    v_cvt_pk_bf16_f32 v31, v86, v87
    buffer_store_dwordx4 v[28:31], v101, s[16:19], s10 offen offset:2048 sc1
    ds_read_b128 v[16:19], v40 offset:0
    ds_read_b128 v[20:23], v40 offset:1024
    ds_read_b128 v[24:27], v40 offset:2048
    ds_read_b128 v[28:31], v40 offset:3072
    s_waitcnt lgkmcnt(0)
    s_barrier
    s_waitcnt vmcnt(4)
    v_lshlrev_b32 v12, 16, v32
    v_and_b32 v13, s11, v32
    v_lshlrev_b32 v6, 16, v16
    v_and_b32 v7, s11, v16
    v_lshlrev_b32 v8, 16, v24
    v_and_b32 v9, s11, v24
    v_mul_f32 v6, v6, v12
    v_mul_f32 v7, v7, v13
    v_mul_f32 v8, v8, v12
    v_mul_f32 v9, v9, v13
    v_cvt_pk_bf16_f32 v10, v6, v7
    v_cvt_pk_bf16_f32 v11, v8, v9
    v_dot2_f32_bf16 v116, v10, v124, v116
    v_dot2_f32_bf16 v118, v11, v124, v118
    v_lshlrev_b32 v12, 16, v33
    v_and_b32 v13, s11, v33
    v_lshlrev_b32 v6, 16, v17
    v_and_b32 v7, s11, v17
    v_lshlrev_b32 v8, 16, v25
    v_and_b32 v9, s11, v25
    v_mul_f32 v6, v6, v12
    v_mul_f32 v7, v7, v13
    v_mul_f32 v8, v8, v12
    v_mul_f32 v9, v9, v13
    v_cvt_pk_bf16_f32 v10, v6, v7
    v_cvt_pk_bf16_f32 v11, v8, v9
    v_dot2_f32_bf16 v116, v10, v124, v116
    v_dot2_f32_bf16 v118, v11, v124, v118
    v_lshlrev_b32 v12, 16, v34
    v_and_b32 v13, s11, v34
    v_lshlrev_b32 v6, 16, v18
    v_and_b32 v7, s11, v18
    v_lshlrev_b32 v8, 16, v26
    v_and_b32 v9, s11, v26
    v_mul_f32 v6, v6, v12
    v_mul_f32 v7, v7, v13
    v_mul_f32 v8, v8, v12
    v_mul_f32 v9, v9, v13
    v_cvt_pk_bf16_f32 v10, v6, v7
    v_cvt_pk_bf16_f32 v11, v8, v9
    v_dot2_f32_bf16 v116, v10, v124, v116
    v_dot2_f32_bf16 v118, v11, v124, v118
    v_lshlrev_b32 v12, 16, v35
    v_and_b32 v13, s11, v35
    v_lshlrev_b32 v6, 16, v19
    v_and_b32 v7, s11, v19
    v_lshlrev_b32 v8, 16, v27
    v_and_b32 v9, s11, v27
    v_mul_f32 v6, v6, v12
    v_mul_f32 v7, v7, v13
    v_mul_f32 v8, v8, v12
    v_mul_f32 v9, v9, v13
    v_cvt_pk_bf16_f32 v10, v6, v7
    v_cvt_pk_bf16_f32 v11, v8, v9
    v_dot2_f32_bf16 v116, v10, v124, v116
    v_dot2_f32_bf16 v118, v11, v124, v118
    v_lshlrev_b32 v12, 16, v36
    v_and_b32 v13, s11, v36
    v_lshlrev_b32 v6, 16, v20
    v_and_b32 v7, s11, v20
    v_lshlrev_b32 v8, 16, v28
    v_and_b32 v9, s11, v28
    v_mul_f32 v6, v6, v12
    v_mul_f32 v7, v7, v13
    v_mul_f32 v8, v8, v12
    v_mul_f32 v9, v9, v13
    v_cvt_pk_bf16_f32 v10, v6, v7
    v_cvt_pk_bf16_f32 v11, v8, v9
    v_dot2_f32_bf16 v116, v10, v124, v116
    v_dot2_f32_bf16 v118, v11, v124, v118
    v_lshlrev_b32 v12, 16, v37
    v_and_b32 v13, s11, v37
    v_lshlrev_b32 v6, 16, v21
    v_and_b32 v7, s11, v21
    v_lshlrev_b32 v8, 16, v29
    v_and_b32 v9, s11, v29
    v_mul_f32 v6, v6, v12
    v_mul_f32 v7, v7, v13
    v_mul_f32 v8, v8, v12
    v_mul_f32 v9, v9, v13
    v_cvt_pk_bf16_f32 v10, v6, v7
    v_cvt_pk_bf16_f32 v11, v8, v9
    v_dot2_f32_bf16 v116, v10, v124, v116
    v_dot2_f32_bf16 v118, v11, v124, v118
    v_lshlrev_b32 v12, 16, v38
    v_and_b32 v13, s11, v38
    v_lshlrev_b32 v6, 16, v22
    v_and_b32 v7, s11, v22
    v_lshlrev_b32 v8, 16, v30
    v_and_b32 v9, s11, v30
    v_mul_f32 v6, v6, v12
    v_mul_f32 v7, v7, v13
    v_mul_f32 v8, v8, v12
    v_mul_f32 v9, v9, v13
    v_cvt_pk_bf16_f32 v10, v6, v7
    v_cvt_pk_bf16_f32 v11, v8, v9
    v_dot2_f32_bf16 v116, v10, v124, v116
    v_dot2_f32_bf16 v118, v11, v124, v118
    v_lshlrev_b32 v12, 16, v39
    v_and_b32 v13, s11, v39
    v_lshlrev_b32 v6, 16, v23
    v_and_b32 v7, s11, v23
    v_lshlrev_b32 v8, 16, v31
    v_and_b32 v9, s11, v31
    v_mul_f32 v6, v6, v12
    v_mul_f32 v7, v7, v13
    v_mul_f32 v8, v8, v12
    v_mul_f32 v9, v9, v13
    v_cvt_pk_bf16_f32 v10, v6, v7
    v_cvt_pk_bf16_f32 v11, v8, v9
    v_dot2_f32_bf16 v116, v10, v124, v116
    v_dot2_f32_bf16 v118, v11, v124, v118
    s_nop 1
    v_add_f32_dpp v116, v116, v116 row_shr:1 row_mask:0xf bank_mask:0xf bound_ctrl:0
    v_add_f32_dpp v118, v118, v118 row_shr:1 row_mask:0xf bank_mask:0xf bound_ctrl:0
    s_nop 0
    v_add_f32_dpp v116, v116, v116 row_shr:2 row_mask:0xf bank_mask:0xf bound_ctrl:0
    v_add_f32_dpp v118, v118, v118 row_shr:2 row_mask:0xf bank_mask:0xf bound_ctrl:0
    s_nop 0
    v_add_f32_dpp v116, v116, v116 row_shr:4 row_mask:0xf bank_mask:0xf bound_ctrl:0
    v_add_f32_dpp v118, v118, v118 row_shr:4 row_mask:0xf bank_mask:0xf bound_ctrl:0
    s_nop 0
    v_add_f32_dpp v116, v116, v116 row_shr:8 row_mask:0xf bank_mask:0xf bound_ctrl:0
    v_add_f32_dpp v118, v118, v118 row_shr:8 row_mask:0xf bank_mask:0xf bound_ctrl:0
    s_nop 0
    v_add_f32_dpp v116, v116, v116 row_bcast:15 row_mask:0xa bank_mask:0xf
    v_add_f32_dpp v118, v118, v118 row_bcast:15 row_mask:0xa bank_mask:0xf
    s_nop 0
    v_add_f32_dpp v116, v116, v116 row_bcast:31 row_mask:0xc bank_mask:0xf
    v_add_f32_dpp v118, v118, v118 row_bcast:31 row_mask:0xc bank_mask:0xf
    v_cvt_pk_bf16_f32 v6, v116, v118
    v_lshlrev_b32 v7, 16, v6
    v_and_b32 v8, s11, v6
    v_mul_f32 v7, 0xbfb8aa3b, v7
    v_mul_f32 v8, 0xbfb8aa3b, v8
    v_exp_f32 v7, v7
    v_exp_f32 v8, v8
    v_add_f32 v7, 1.0, v7
    v_add_f32 v8, 1.0, v8
    v_rcp_f32 v7, v7
    v_rcp_f32 v8, v8
    s_nop 0
    v_cvt_pk_bf16_f32 v6, v7, v8
    v_lshlrev_b32 v116, 16, v6
    v_and_b32 v118, s11, v6
    v_sub_f32 v7, 1.0, v116
    v_sub_f32 v8, 1.0, v118
    v_cvt_pk_bf16_f32 v6, v7, v8
    v_lshlrev_b32 v117, 16, v6
    v_and_b32 v119, s11, v6
    v_mul_f32 v116, 0x34800000, v116
    v_mul_f32 v117, 0x34800000, v117
    v_mul_f32 v118, 0x34800000, v118
    v_mul_f32 v119, 0x34800000, v119
    s_lshl_b32 s30, s51, 4
    s_add_u32 s30, s30, 65536
    v_mov_b32 v9, s30
    s_mov_b32 exec_lo, 0
    s_mov_b32 exec_hi, 0x80000000
    ds_write_b128 v9, v[116:119]
    s_mov_b64 exec, -1
    v_mov_b32 v9, 65920
    v_mov_b32 v10, 1
    v_mov_b32 v48, s48
    v_mov_b32 v49, s48
    v_mov_b32 v50, s48
    v_mov_b32 v51, s48
    s_mov_b64 exec, 1
    s_waitcnt vmcnt(0)
    ds_add_rtn_u32 v11, v9, v10
    s_waitcnt lgkmcnt(0)
    v_readfirstlane_b32 s30, v11
    s_cmp_eq_u32 s30, 3
    s_cselect_b32 exec_lo, -1, 0
    s_cselect_b32 exec_hi, -1, 0
    buffer_store_dwordx4 v[48:51], v2, s[16:19], s57 offen sc1
    s_mov_b64 exec, -1
    s_setprio 0
    v_lshrrev_b32 v5, 4, v0
    v_and_b32 v6, 15, v0
    v_lshrrev_b32 v8, 2, v0
    v_mul_u32_u24 v27, 264192, v8
    v_and_b32 v8, 3, v0
    v_lshl_add_u32 v27, v8, 4, v27
    s_lshl_b32 s27, s3, 11
    s_mul_i32 s23, s3, 6144
    s_add_u32 s23, s23, 16384
    v_bfe_u32 v8, v0, 1, 4
    v_and_b32 v9, 1, v0
    v_lshl_add_u32 v8, v8, 4, v9
    v_lshlrev_b32 v7, 10, v8
    s_lshl_b32 s28, s3, 8
    s_and_b32 s8, s2, 7
    s_lshl_b32 s8, s8, 7
    s_add_u32 s8, s8, s27
    s_add_u32 s8, s8, 0x00e20000
    v_lshlrev_b32 v8, 4, v6
    v_lshl_or_b32 v9, v5, 9, v8
    v_add_u32 v25, s27, v9
    v_add_u32 v30, s23, v9
    v_lshl_or_b32 v26, v5, 12, v8
    v_add_u32 v26, s28, v26
    v_mul_u32_u24 v31, 12288, v5
    s_add_u32 s29, s28, 16384
    v_add3_u32 v31, v31, v8, s29
    v_mul_u32_u24 v24, 1056768, v5
    v_lshl_add_u32 v24, v6, 2, v24
    s_mul_i32 s24, s3, 33024
    s_lshl_b32 s26, s53, 6
    s_add_u32 s24, s24, s26
    s_add_u32 s26, s24, 16512
    v_lshlrev_b32 v8, 2, v6
    v_lshl_or_b32 v28, v5, 8, v8
    v_add_u32 v28, s27, v28
    s_and_b32 s29, s55, 15
    s_add_u32 s29, s29, s23
    v_mul_u32_u24 v29, 192, v5
    v_lshl_add_u32 v29, v6, 1, v29
    v_add_u32 v29, s29, v29
    s_lshl_b32 s30, s53, 15
    s_add_u32 s30, s30, s28
    s_add_u32 s30, s30, 0x00500000
    s_add_u32 s31, s30, 4096
    s_lshl_b32 s9, s53, 10
    s_lshl_b32 s10, s3, 7
    s_add_u32 s9, s9, s10
    s_add_u32 s9, s9, 0x00e80000
    s_mul_i32 s50, s3, 33024
    s_and_b32 s29, s2, 7
    s_lshl_b32 s29, s29, 4
    s_add_u32 s50, s50, s29
    s_add_u32 s50, s50, 16384
    s_cmp_eq_u32 s54, 0
    s_cselect_b32 s52, 0x00010001, 0
    v_bfe_u32 v8, v0, 4, 1
    v_lshl_add_u32 v8, v6, 4, v8
    v_mul_u32_u24 v2, 16512, v8
    s_cselect_b32 s59, -1, 0
    v_mul_u32_u24 v8, 43, v0
    v_lshrrev_b32 v8, 7, v8
    v_mul_u32_u24 v9, 3, v8
    v_sub_u32 v9, v0, v9
    v_mul_u32_u24 v112, 131328, v8
    v_lshl_add_u32 v112, v9, 4, v112
    v_cvt_f32_u32 v14, v6
    v_cvt_f32_u32 v15, v5
    v_mul_f32 v15, 4.0, v15
    v_cvt_f32_u32 v16, s3
    v_mul_f32 v16, 0x3c000000, v16
    v_mul_f32 v18, v14, v16
    v_fmamk_f32 v19, v14, 0x3b800000, v18
    v_mul_f32 v14, 0x3d800000, v14
    v_mul_f32 v20, v15, v14
    v_cos_f32 v11, v20
    v_sin_f32 v12, v20
    v_mov_b32 v32, 0
    v_cvt_pk_bf16_f32 v72, v11, v12
    v_cvt_pk_bf16_f32 v76, -v12, v11
    v_add_f32 v15, 1.0, v15
    v_mul_f32 v21, v15, v14
    v_cos_f32 v11, v21
    v_sin_f32 v12, v21
    v_mov_b32 v33, 0
    v_cvt_pk_bf16_f32 v73, v11, v12
    v_cvt_pk_bf16_f32 v77, -v12, v11
    v_add_f32 v15, 1.0, v15
    v_mul_f32 v22, v15, v14
    v_cos_f32 v11, v22
    v_sin_f32 v12, v22
    v_mov_b32 v34, 0
    v_cvt_pk_bf16_f32 v74, v11, v12
    v_cvt_pk_bf16_f32 v78, -v12, v11
    v_add_f32 v15, 1.0, v15
    v_mul_f32 v23, v15, v14
    v_cos_f32 v11, v23
    v_sin_f32 v12, v23
    v_mov_b32 v35, 0
    v_cvt_pk_bf16_f32 v75, v11, v12
    v_cvt_pk_bf16_f32 v79, -v12, v11
    v_fma_f32 v8, v15, v16, v23
    v_fmamk_f32 v9, v15, 0x3b800000, v8
    v_cos_f32 v11, v8
    v_sin_f32 v12, v8
    v_add_f32 v10, v23, v18
    v_cvt_pk_bf16_f32 v83, v11, v12
    v_cvt_pk_bf16_f32 v87, -v12, v11
    v_cos_f32 v11, v9
    v_sin_f32 v12, v9
    v_add_f32 v13, v23, v19
    v_cvt_pk_bf16_f32 v91, v11, v12
    v_cvt_pk_bf16_f32 v95, -v12, v11
    v_cos_f32 v11, v10
    v_sin_f32 v12, v10
    v_subrev_f32 v15, 1.0, v15
    v_cvt_pk_bf16_f32 v99, v11, v12
    v_cvt_pk_bf16_f32 v103, -v12, v11
    v_cos_f32 v11, v13
    v_sin_f32 v12, v13
    v_mov_b32 v36, 0
    v_cvt_pk_bf16_f32 v107, v11, v12
    v_cvt_pk_bf16_f32 v111, -v12, v11
    v_fma_f32 v8, v15, v16, v22
    v_fmamk_f32 v9, v15, 0x3b800000, v8
    v_cos_f32 v11, v8
    v_sin_f32 v12, v8
    v_add_f32 v10, v22, v18
    v_cvt_pk_bf16_f32 v82, v11, v12
    v_cvt_pk_bf16_f32 v86, -v12, v11
    v_cos_f32 v11, v9
    v_sin_f32 v12, v9
    v_add_f32 v13, v22, v19
    v_cvt_pk_bf16_f32 v90, v11, v12
    v_cvt_pk_bf16_f32 v94, -v12, v11
    v_cos_f32 v11, v10
    v_sin_f32 v12, v10
    v_subrev_f32 v15, 1.0, v15
    v_cvt_pk_bf16_f32 v98, v11, v12
    v_cvt_pk_bf16_f32 v102, -v12, v11
    v_cos_f32 v11, v13
    v_sin_f32 v12, v13
    v_mov_b32 v37, 0
    v_cvt_pk_bf16_f32 v106, v11, v12
    v_cvt_pk_bf16_f32 v110, -v12, v11
    v_fma_f32 v8, v15, v16, v21
    v_fmamk_f32 v9, v15, 0x3b800000, v8
    v_cos_f32 v11, v8
    v_sin_f32 v12, v8
    v_add_f32 v10, v21, v18
    v_cvt_pk_bf16_f32 v81, v11, v12
    v_cvt_pk_bf16_f32 v85, -v12, v11
    v_cos_f32 v11, v9
    v_sin_f32 v12, v9
    v_add_f32 v13, v21, v19
    v_cvt_pk_bf16_f32 v89, v11, v12
    v_cvt_pk_bf16_f32 v93, -v12, v11
    v_cos_f32 v11, v10
    v_sin_f32 v12, v10
    v_subrev_f32 v15, 1.0, v15
    v_cvt_pk_bf16_f32 v97, v11, v12
    v_cvt_pk_bf16_f32 v101, -v12, v11
    v_cos_f32 v11, v13
    v_sin_f32 v12, v13
    v_mov_b32 v38, 0
    v_cvt_pk_bf16_f32 v105, v11, v12
    v_cvt_pk_bf16_f32 v109, -v12, v11
    v_fma_f32 v8, v15, v16, v20
    v_fmamk_f32 v9, v15, 0x3b800000, v8
    v_cos_f32 v11, v8
    v_sin_f32 v12, v8
    v_add_f32 v10, v20, v18
    v_cvt_pk_bf16_f32 v80, v11, v12
    v_cvt_pk_bf16_f32 v84, -v12, v11
    v_cos_f32 v11, v9
    v_sin_f32 v12, v9
    v_add_f32 v13, v20, v19
    v_cvt_pk_bf16_f32 v88, v11, v12
    v_cvt_pk_bf16_f32 v92, -v12, v11
    v_cos_f32 v11, v10
    v_sin_f32 v12, v10
    v_subrev_f32 v15, 1.0, v15
    v_cvt_pk_bf16_f32 v96, v11, v12
    v_cvt_pk_bf16_f32 v100, -v12, v11
    v_cos_f32 v11, v13
    v_sin_f32 v12, v13
    v_mov_b32 v39, 0
    v_cvt_pk_bf16_f32 v104, v11, v12
    v_cvt_pk_bf16_f32 v108, -v12, v11
    v_mov_b32 v40, 0
    v_mov_b32 v41, 0
    v_mov_b32 v42, 0
    v_mov_b32 v43, 0
    v_mov_b32 v44, 0
    v_mov_b32 v45, 0
    v_mov_b32 v46, 0
    v_mov_b32 v47, 0
    v_mov_b32 v48, 0
    v_mov_b32 v49, 0
    v_mov_b32 v50, 0
    v_mov_b32 v51, 0
    v_mov_b32 v52, 0
    v_mov_b32 v53, 0
    v_mov_b32 v54, 0
    v_mov_b32 v55, 0
    v_mov_b32 v56, 0
    v_mov_b32 v57, 0
    v_mov_b32 v58, 0
    v_mov_b32 v59, 0
    v_mov_b32 v60, 0
    v_mov_b32 v61, 0
    v_mov_b32 v62, 0
    v_mov_b32 v63, 0
    v_add_f32 v16, 0x3c000000, v16
    v_mov_b32 v17, v15
    v_add_f32 v17, 1.0, v17
    v_fma_f32 v20, v17, v16, v20
    v_add_f32 v17, 1.0, v17
    v_fma_f32 v21, v17, v16, v21
    v_add_f32 v17, 1.0, v17
    v_fma_f32 v22, v17, v16, v22
    v_add_f32 v17, 1.0, v17
    v_fma_f32 v23, v17, v16, v23
    v_cos_f32 v18, v20
    v_sin_f32 v19, v20
    s_nop 0
    v_cvt_pk_bf16_f32 v8, v18, v19
    v_cvt_pk_bf16_f32 v12, -v19, v18
    v_cos_f32 v18, v21
    v_sin_f32 v19, v21
    s_nop 0
    v_cvt_pk_bf16_f32 v9, v18, v19
    v_cvt_pk_bf16_f32 v13, -v19, v18
    v_cos_f32 v18, v22
    v_sin_f32 v19, v22
    s_nop 0
    v_cvt_pk_bf16_f32 v10, v18, v19
    v_cvt_pk_bf16_f32 v14, -v19, v18
    v_cos_f32 v18, v23
    v_sin_f32 v19, v23
    s_nop 0
    v_cvt_pk_bf16_f32 v11, v18, v19
    v_cvt_pk_bf16_f32 v15, -v19, v18
L_p2:
    s_barrier
    s_mov_b32 s58, 0
    s_mov_b32 exec_hi, 0
L_poll1:
    buffer_load_dword v64, v7, s[16:19], s8 offen sc1
    s_add_u32 s58, s58, 1
    s_waitcnt vmcnt(0)
    v_cmp_ne_u32 vcc, s48, v64
    s_cmp_gt_u32 s58, 400000
    s_cbranch_scc1 L_poll1_d
    s_and_b64 exec, exec, vcc
    s_cbranch_execz L_poll1_d
    s_branch L_poll1
L_poll1_d:
    s_mov_b64 exec, -1
L_p2c:
    s_setprio 1
    s_mov_b32 m0, s27
    s_nop 0
    buffer_load_dwordx4 v27, s[16:19], s24 offen sc1 lds
    s_add_u32 m0, s27, 1024
    s_nop 0
    buffer_load_dwordx4 v27, s[16:19], s26 offen sc1 lds
    s_barrier
    s_not_b32 exec_lo, s52
    s_not_b32 exec_hi, s52
    ds_read_u16_d16_hi v40, v29 offset:3072
    ds_read_u16_d16_hi v42, v29 offset:3120
    ds_read_u16_d16_hi v44, v29 offset:3168
    ds_read_u16_d16_hi v46, v29 offset:3216
    ds_read_u16_d16_hi v41, v29 offset:4608
    ds_read_u16_d16_hi v43, v29 offset:4656
    ds_read_u16_d16_hi v45, v29 offset:4704
    ds_read_u16_d16_hi v47, v29 offset:4752
    ds_read_u16_d16_hi v56, v29 offset:3840
    ds_read_u16_d16_hi v58, v29 offset:3888
    ds_read_u16_d16_hi v60, v29 offset:3936
    ds_read_u16_d16_hi v62, v29 offset:3984
    ds_read_u16_d16_hi v57, v29 offset:5376
    ds_read_u16_d16_hi v59, v29 offset:5424
    ds_read_u16_d16_hi v61, v29 offset:5472
    ds_read_u16_d16_hi v63, v29 offset:5520
    s_mov_b64 exec, -1
    s_not_b32 exec_lo, s52
    s_not_b32 exec_hi, s52
    ds_read_u16_d16_hi v32, v29 offset:0
    ds_read_u16_d16_hi v34, v29 offset:48
    ds_read_u16_d16_hi v36, v29 offset:96
    ds_read_u16_d16_hi v38, v29 offset:144
    ds_read_u16_d16_hi v33, v29 offset:1536
    ds_read_u16_d16_hi v35, v29 offset:1584
    ds_read_u16_d16_hi v37, v29 offset:1632
    ds_read_u16_d16_hi v39, v29 offset:1680
    ds_read_u16_d16_hi v48, v29 offset:768
    ds_read_u16_d16_hi v50, v29 offset:816
    ds_read_u16_d16_hi v52, v29 offset:864
    ds_read_u16_d16_hi v54, v29 offset:912
    ds_read_u16_d16_hi v49, v29 offset:2304
    ds_read_u16_d16_hi v51, v29 offset:2352
    ds_read_u16_d16_hi v53, v29 offset:2400
    ds_read_u16_d16_hi v55, v29 offset:2448
    s_mov_b64 exec, -1
    s_waitcnt vmcnt(0)
    s_lshl_b32 s25, s3, 9
    s_add_u32 s25, s25, 65936
    s_mov_b32 m0, s25
    s_mov_b32 exec_lo, s59
    s_mov_b32 exec_hi, 0
    buffer_load_dwordx4 v2, s[16:19], s50 offen sc1 lds
    s_mov_b64 exec, -1
    ds_read2_b32 v[64:65], v28 offset0:0 offset1:16
    ds_read2_b32 v[66:67], v28 offset0:32 offset1:48
    v_add_u32 v28, 1024, v28
    ds_read2_b32 v[68:69], v28 offset0:0 offset1:16
    ds_read2_b32 v[70:71], v28 offset0:32 offset1:48
L_p2e:
    s_waitcnt lgkmcnt(2)
    v_mfma_f32_16x16x32_bf16 v[112:115], v[72:75], v[64:67], 0
    v_mfma_f32_16x16x32_bf16 v[116:119], v[76:79], v[64:67], 0
    s_waitcnt lgkmcnt(0)
    v_mfma_f32_16x16x32_bf16 v[120:123], v[72:75], v[68:71], 0
    v_mfma_f32_16x16x32_bf16 v[124:127], v[76:79], v[68:71], 0
    s_nop 4
    v_cvt_pk_bf16_f32 v16, v112, v116
    s_nop 1
    v_cvt_pk_bf16_f32 v17, v120, v124
    v_cvt_pk_bf16_f32 v18, v113, v117
    v_cvt_pk_bf16_f32 v19, v121, v125
    ds_write_b128 v25, v[16:19] offset:0
    v_cvt_pk_bf16_f32 v20, v114, v118
    v_cvt_pk_bf16_f32 v21, v122, v126
    v_cvt_pk_bf16_f32 v22, v115, v119
    v_cvt_pk_bf16_f32 v23, v123, v127
    ds_write_b128 v25, v[20:23] offset:256
    s_waitcnt lgkmcnt(0)
    v_mov_b32 v64, s48
    v_lshlrev_b32 v65, 2, v0
    s_mov_b32 exec_hi, 0
    buffer_store_dword v64, v65, s[16:19], s9 offen sc1
    s_mov_b32 exec_hi, -1
    s_barrier
    ds_read_b64 v[64:65], v26 offset:0
    ds_read_b64 v[66:67], v26 offset:2048
    ds_read_b64 v[68:69], v26 offset:8
    ds_read_b64 v[70:71], v26 offset:2056
    s_waitcnt lgkmcnt(2)
    v_mfma_f32_16x16x32_bf16 v[112:115], v[80:83], v[64:67], 0
    v_mfma_f32_16x16x32_bf16 v[116:119], v[84:87], v[64:67], 0
    s_waitcnt lgkmcnt(0)
    v_mfma_f32_16x16x32_bf16 v[120:123], v[88:91], v[68:71], 0
    v_mfma_f32_16x16x32_bf16 v[124:127], v[92:95], v[68:71], 0
    s_cmp_lg_u32 s54, 0
    s_cbranch_scc0 L_el
L_elb:
    s_nop 1
    v_mul_f32 v27, v112, v40
    v_mul_f32 v28, v116, v40
    v_fma_f32 v27, -v116, v41, v27
    v_fmac_f32 v28, v112, v41
    v_cvt_pk_bf16_f32 v16, v28, v27
    v_mul_f32 v26, v113, v42
    v_mul_f32 v25, v117, v42
    v_fma_f32 v26, -v117, v43, v26
    v_fmac_f32 v25, v113, v43
    v_cvt_pk_bf16_f32 v17, v25, v26
    v_mul_f32 v27, v114, v44
    v_mul_f32 v28, v118, v44
    v_fma_f32 v27, -v118, v45, v27
    v_fmac_f32 v28, v114, v45
    v_cvt_pk_bf16_f32 v18, v28, v27
    v_mul_f32 v26, v115, v46
    v_mul_f32 v25, v119, v46
    v_fma_f32 v26, -v119, v47, v26
    v_fmac_f32 v25, v115, v47
    v_cvt_pk_bf16_f32 v19, v25, v26
    s_nop 1
    v_mfma_f32_16x16x32_bf16 v[40:43], v[96:99], v[16:19], 0
    v_mfma_f32_16x16x32_bf16 v[44:47], v[100:103], v[16:19], 0
    v_mul_f32 v27, v120, v56
    v_mul_f32 v28, v124, v56
    v_fma_f32 v27, -v124, v57, v27
    v_fmac_f32 v28, v120, v57
    v_cvt_pk_bf16_f32 v20, v28, v27
    v_mul_f32 v26, v121, v58
    v_mul_f32 v25, v125, v58
    v_fma_f32 v26, -v125, v59, v26
    v_fmac_f32 v25, v121, v59
    v_cvt_pk_bf16_f32 v21, v25, v26
    v_mul_f32 v27, v122, v60
    v_mul_f32 v28, v126, v60
    v_fma_f32 v27, -v126, v61, v27
    v_fmac_f32 v28, v122, v61
    v_cvt_pk_bf16_f32 v22, v28, v27
    v_mul_f32 v26, v123, v62
    v_mul_f32 v25, v127, v62
    v_fma_f32 v26, -v127, v63, v26
    v_fmac_f32 v25, v123, v63
    v_cvt_pk_bf16_f32 v23, v25, v26
    s_nop 1
    v_mfma_f32_16x16x32_bf16 v[56:59], v[104:107], v[20:23], 0
    v_mfma_f32_16x16x32_bf16 v[60:63], v[108:111], v[20:23], 0
    v_cvt_pk_bf16_f32 v16, v40, v44
    v_cvt_pk_bf16_f32 v18, v41, v45
    s_nop 5
    v_cvt_pk_bf16_f32 v17, v56, v60
    v_cvt_pk_bf16_f32 v19, v57, v61
    ds_write_b128 v30, v[16:19] offset:3072
    v_cvt_pk_bf16_f32 v20, v42, v46
    v_cvt_pk_bf16_f32 v22, v43, v47
    v_cvt_pk_bf16_f32 v21, v58, v62
    v_cvt_pk_bf16_f32 v23, v59, v63
    ds_write_b128 v30, v[20:23] offset:3328
    s_waitcnt lgkmcnt(0)
    s_barrier
L_spb:
    ds_read_b64 v[56:57], v31 offset:3072
    ds_read_b64 v[58:59], v31 offset:9216
    ds_read_b64 v[60:61], v31 offset:3080
    ds_read_b64 v[62:63], v31 offset:9224
    s_waitcnt lgkmcnt(2)
    v_mfma_f32_16x16x32_bf16 v[40:43], v[72:75], v[56:59], 0
    v_mfma_f32_16x16x32_bf16 v[44:47], v[76:79], v[56:59], 0
    s_waitcnt lgkmcnt(0)
    v_mfma_f32_16x16x32_bf16 v[80:83], v[72:75], v[60:63], 0
    v_mfma_f32_16x16x32_bf16 v[84:87], v[76:79], v[60:63], 0
    v_mul_f32 v27, v112, v32
    v_mul_f32 v28, v116, v32
    v_fma_f32 v27, -v116, v33, v27
    v_fmac_f32 v28, v112, v33
    v_cvt_pk_bf16_f32 v16, v28, v27
    v_mul_f32 v26, v113, v34
    v_mul_f32 v25, v117, v34
    v_fma_f32 v26, -v117, v35, v26
    v_fmac_f32 v25, v113, v35
    v_cvt_pk_bf16_f32 v17, v25, v26
    v_mul_f32 v27, v114, v36
    v_mul_f32 v28, v118, v36
    v_fma_f32 v27, -v118, v37, v27
    v_fmac_f32 v28, v114, v37
    v_cvt_pk_bf16_f32 v18, v28, v27
    v_mul_f32 v26, v115, v38
    v_mul_f32 v25, v119, v38
    v_fma_f32 v26, -v119, v39, v26
    v_fmac_f32 v25, v115, v39
    v_cvt_pk_bf16_f32 v19, v25, v26
    s_nop 1
    v_mfma_f32_16x16x32_bf16 v[32:35], v[96:99], v[16:19], 0
    v_mfma_f32_16x16x32_bf16 v[36:39], v[100:103], v[16:19], 0
    v_cvt_pk_bf16_f32 v40, v44, v40
    s_add_u32 s30, s24, 0x00500000
    buffer_store_dword v40, v24, s[16:19], s30 offen sc1
    v_cvt_pk_bf16_f32 v41, v45, v41
    s_add_u32 s30, s24, 0x00540800
    buffer_store_dword v41, v24, s[16:19], s30 offen sc1
    v_cvt_pk_bf16_f32 v42, v46, v42
    s_add_u32 s30, s24, 0x00581000
    buffer_store_dword v42, v24, s[16:19], s30 offen sc1
    v_cvt_pk_bf16_f32 v43, v47, v43
    s_add_u32 s30, s24, 0x005c1800
    buffer_store_dword v43, v24, s[16:19], s30 offen sc1
    v_mul_f32 v27, v120, v48
    v_mul_f32 v28, v124, v48
    v_fma_f32 v27, -v124, v49, v27
    v_fmac_f32 v28, v120, v49
    v_cvt_pk_bf16_f32 v20, v28, v27
    v_mul_f32 v26, v121, v50
    v_mul_f32 v25, v125, v50
    v_fma_f32 v26, -v125, v51, v26
    v_fmac_f32 v25, v121, v51
    v_cvt_pk_bf16_f32 v21, v25, v26
    v_mul_f32 v27, v122, v52
    v_mul_f32 v28, v126, v52
    v_fma_f32 v27, -v126, v53, v27
    v_fmac_f32 v28, v122, v53
    v_cvt_pk_bf16_f32 v22, v28, v27
    v_mul_f32 v26, v123, v54
    v_mul_f32 v25, v127, v54
    v_fma_f32 v26, -v127, v55, v26
    v_fmac_f32 v25, v123, v55
    v_cvt_pk_bf16_f32 v23, v25, v26
    s_nop 1
    v_mfma_f32_16x16x32_bf16 v[48:51], v[104:107], v[20:23], 0
    v_mfma_f32_16x16x32_bf16 v[52:55], v[108:111], v[20:23], 0
    v_cvt_pk_bf16_f32 v80, v84, v80
    s_add_u32 s30, s24, 0x00504080
    buffer_store_dword v80, v24, s[16:19], s30 offen sc1
    v_cvt_pk_bf16_f32 v81, v85, v81
    s_add_u32 s30, s24, 0x00544880
    buffer_store_dword v81, v24, s[16:19], s30 offen sc1
    v_cvt_pk_bf16_f32 v82, v86, v82
    s_add_u32 s30, s24, 0x00585080
    buffer_store_dword v82, v24, s[16:19], s30 offen sc1
    v_cvt_pk_bf16_f32 v83, v87, v83
    s_add_u32 s30, s24, 0x005c5880
    buffer_store_dword v83, v24, s[16:19], s30 offen sc1
    v_cvt_pk_bf16_f32 v112, v32, v36
    v_cvt_pk_bf16_f32 v114, v33, v37
    v_cvt_pk_bf16_f32 v113, v48, v52
    v_cvt_pk_bf16_f32 v115, v49, v53
    ds_write_b128 v30, v[112:115] offset:0
    v_cvt_pk_bf16_f32 v116, v34, v38
    v_cvt_pk_bf16_f32 v118, v35, v39
    v_cvt_pk_bf16_f32 v117, v50, v54
    v_cvt_pk_bf16_f32 v119, v51, v55
    ds_write_b128 v30, v[116:119] offset:256
    s_waitcnt lgkmcnt(0)
    s_barrier
    ds_read_b64 v[56:57], v31 offset:0
    ds_read_b64 v[58:59], v31 offset:6144
    ds_read_b64 v[60:61], v31 offset:8
    ds_read_b64 v[62:63], v31 offset:6152
    s_waitcnt lgkmcnt(2)
    v_mfma_f32_16x16x32_bf16 v[96:99], v[72:75], v[56:59], 0
    v_mfma_f32_16x16x32_bf16 v[100:103], v[76:79], v[56:59], 0
    s_waitcnt lgkmcnt(0)
    v_mfma_f32_16x16x32_bf16 v[104:107], v[72:75], v[60:63], 0
    v_mfma_f32_16x16x32_bf16 v[108:111], v[76:79], v[60:63], 0
    s_nop 4
    v_cvt_pk_bf16_f32 v96, v100, v96
    s_add_u32 s30, s24, 0x00000000
    buffer_store_dword v96, v24, s[16:19], s30 offen sc1
    v_cvt_pk_bf16_f32 v97, v101, v97
    s_add_u32 s30, s24, 0x00040800
    buffer_store_dword v97, v24, s[16:19], s30 offen sc1
    v_cvt_pk_bf16_f32 v98, v102, v98
    s_add_u32 s30, s24, 0x00081000
    buffer_store_dword v98, v24, s[16:19], s30 offen sc1
    v_cvt_pk_bf16_f32 v99, v103, v99
    s_add_u32 s30, s24, 0x000c1800
    buffer_store_dword v99, v24, s[16:19], s30 offen sc1
    v_cvt_pk_bf16_f32 v104, v108, v104
    s_add_u32 s30, s24, 0x00004080
    buffer_store_dword v104, v24, s[16:19], s30 offen sc1
    v_cvt_pk_bf16_f32 v105, v109, v105
    s_add_u32 s30, s24, 0x00044880
    buffer_store_dword v105, v24, s[16:19], s30 offen sc1
    v_cvt_pk_bf16_f32 v106, v110, v106
    s_add_u32 s30, s24, 0x00085080
    buffer_store_dword v106, v24, s[16:19], s30 offen sc1
    v_cvt_pk_bf16_f32 v107, v111, v107
    s_add_u32 s30, s24, 0x000c5880
    buffer_store_dword v107, v24, s[16:19], s30 offen sc1
    s_mov_b32 s27, s9
    s_setprio 0
    v_bfe_u32 v8, v0, 2, 2
    v_lshlrev_b32 v9, 4, v8
    v_add_u32 v9, 65536, v9
    ds_read_b128 v[96:99], v9
    v_lshlrev_b32 v9, 2, v6
    v_lshl_or_b32 v1, v5, 12, v9
    v_lshl_or_b32 v2, v5, 20, v9
    s_xor_b32 s50, s3, 4
    s_mul_i32 s8, s2, 16512
    s_lshl_b32 s11, s50, 6
    s_add_u32 s8, s8, s11
    s_add_u32 s10, s8, 0x00500000
    v_bfe_u32 v9, v0, 2, 3
    v_and_b32 v10, 3, v0
    v_lshlrev_b32 v10, 3, v10
    v_lshl_add_u32 v9, v9, 5, v10
    v_add_u32 v9, s50, v9
    s_cmp_eq_u32 s50, 0
    s_cselect_b32 s24, 0x00010001, 0
    v_lshlrev_b32 v7, 10, v9
    s_bfe_u32 s11, s2, 0x30001
    s_lshl_b32 s11, s11, 7
    s_add_u32 s11, s11, 0x00e80000
    v_bfe_u32 v9, v0, 1, 1
    v_cvt_f32_u32 v48, v9
    v_mul_f32 v48, -0.5, v48
    v_add_f32 v48, 0x3e800000, v48
    v_and_b32 v9, 1, v0
    v_cvt_f32_u32 v9, v9
    v_mul_f32 v49, v9, v48
    v_lshlrev_b32 v8, 9, v8
    v_add_u32 v8, s2, v8
    v_cvt_f32_u32 v50, v8
    v_mul_f32 v50, 0xba000000, v50
    v_cvt_f32_u32 v10, v5
    v_add_f32 v10, v10, v10
    v_fma_f32 v51, v10, v50, v49
    v_sub_f32 v52, v51, v48
    v_fmamk_f32 v52, v10, 0xbe000000, v52
    v_cos_f32 v72, v51
    v_sin_f32 v73, v51
    v_cos_f32 v74, v52
    v_sin_f32 v75, v52
    v_add_f32 v51, v51, v50
    v_add_f32 v52, v52, v50
    v_add_f32 v52, 0xbe000000, v52
    v_cos_f32 v76, v51
    v_sin_f32 v77, v51
    v_cos_f32 v78, v52
    v_sin_f32 v79, v52
    s_lshl_b32 s25, s50, 4
    v_lshlrev_b32 v54, 12, v5
    v_add_u32 v53, s25, v6
    v_and_b32 v11, 14, v53
    v_lshl_or_b32 v11, v11, 3, v54
    v_and_b32 v12, 31, v53
    v_lshl_or_b32 v11, v12, 7, v11
    v_bfe_u32 v12, v53, 5, 2
    v_lshl_or_b32 v60, v12, 2, v11
    v_sub_u32 v13, 0, v53
    v_and_b32 v12, 31, v13
    v_lshl_or_b32 v11, v12, 7, v54
    v_and_b32 v12, 14, v13
    v_lshl_or_b32 v11, v12, 3, v11
    v_lshrrev_b32 v13, 3, v13
    v_and_b32 v12, 0x7c, v13
    v_xor_b32 v61, v12, v11
    v_subrev_u32 v13, 16, v13
    v_and_b32 v12, 0x7c, v13
    v_xor_b32 v62, v12, v11
    v_subrev_u32 v13, 16, v13
    v_and_b32 v12, 0x7c, v13
    v_xor_b32 v63, v12, v11
    v_subrev_u32 v13, 16, v13
    v_and_b32 v12, 0x7c, v13
    v_xor_b32 v15, v12, v11
    s_mov_b32 exec_lo, s24
    s_mov_b32 exec_hi, s24
    v_or_b32 v61, 64, v54
    s_mov_b64 exec, -1
    s_waitcnt lgkmcnt(0)
    v_mul_f32 v8, v96, v72
    v_mul_f32 v9, v96, v73
    v_fmac_f32 v8, v98, v74
    v_fmac_f32 v9, v98, v75
    v_cvt_pk_bf16_f32 v56, v8, v9
    v_mul_f32 v8, v97, v72
    v_mul_f32 v9, v97, v73
    v_fmac_f32 v8, v99, v74
    v_fmac_f32 v9, v99, v75
    v_cvt_pk_bf16_f32 v57, v8, v9
    v_mul_f32 v8, v96, v76
    v_mul_f32 v9, v96, v77
    v_fmac_f32 v8, v98, v78
    v_fmac_f32 v9, v98, v79
    v_cvt_pk_bf16_f32 v58, v8, v9
    v_mul_f32 v8, v97, v76
    v_mul_f32 v9, v97, v77
    v_fmac_f32 v8, v99, v78
    v_fmac_f32 v9, v99, v79
    v_cvt_pk_bf16_f32 v59, v8, v9
    v_mov_b32 v8, s49
    v_lshlrev_b32 v9, 2, v0
    s_waitcnt vmcnt(0)
    s_mov_b32 exec_hi, 0
    buffer_store_dword v8, v9, s[16:19], s27 offen sc1
    s_mov_b32 exec_hi, -1
    s_cmp_eq_u32 s3, 4
    s_cbranch_scc1 L_m0
    s_cmp_ge_u32 s3, 4
    s_cbranch_scc1 L_p3b
    v_cvt_f32_u32 v48, v3
    v_cvt_f32_u32 v49, v4
    v_mul_f32 v48, 0x3d000000, v48
    v_mul_f32 v49, 4.0, v49
    v_mul_f32 v49, v48, v49
    v_mov_b32 v8, v49
    v_cos_f32 v9, v8
    v_sin_f32 v10, v8
    v_mul_f32 v8, 0x3d000000, v8
    v_cvt_pk_bf16_f32 v16, v9, -v10
    v_cvt_pk_bf16_f32 v32, v10, v9
    v_cos_f32 v64, v8
    v_sin_f32 v88, v8
    v_fmamk_f32 v8, v48, 0x3f800000, v49
    v_cos_f32 v9, v8
    v_sin_f32 v10, v8
    v_mul_f32 v8, 0x3d000000, v8
    v_cvt_pk_bf16_f32 v17, v9, -v10
    v_cvt_pk_bf16_f32 v33, v10, v9
    v_cos_f32 v65, v8
    v_sin_f32 v89, v8
    v_fmamk_f32 v8, v48, 0x40000000, v49
    v_cos_f32 v9, v8
    v_sin_f32 v10, v8
    v_mul_f32 v8, 0x3d000000, v8
    v_cvt_pk_bf16_f32 v18, v9, -v10
    v_cvt_pk_bf16_f32 v34, v10, v9
    v_cos_f32 v66, v8
    v_sin_f32 v90, v8
    v_fmamk_f32 v8, v48, 0x40400000, v49
    v_cos_f32 v9, v8
    v_sin_f32 v10, v8
    v_mul_f32 v8, 0x3d000000, v8
    v_cvt_pk_bf16_f32 v19, v9, -v10
    v_cvt_pk_bf16_f32 v35, v10, v9
    v_cos_f32 v67, v8
    v_sin_f32 v91, v8
    v_fmamk_f32 v8, v48, 0x41000000, v49
    v_cos_f32 v9, v8
    v_sin_f32 v10, v8
    v_mul_f32 v8, 0x3d000000, v8
    v_cvt_pk_bf16_f32 v20, v9, -v10
    v_cvt_pk_bf16_f32 v36, v10, v9
    v_cos_f32 v68, v8
    v_sin_f32 v92, v8
    v_fmamk_f32 v8, v48, 0x41100000, v49
    v_cos_f32 v9, v8
    v_sin_f32 v10, v8
    v_mul_f32 v8, 0x3d000000, v8
    v_cvt_pk_bf16_f32 v21, v9, -v10
    v_cvt_pk_bf16_f32 v37, v10, v9
    v_cos_f32 v69, v8
    v_sin_f32 v93, v8
    v_fmamk_f32 v8, v48, 0x41200000, v49
    v_cos_f32 v9, v8
    v_sin_f32 v10, v8
    v_mul_f32 v8, 0x3d000000, v8
    v_cvt_pk_bf16_f32 v22, v9, -v10
    v_cvt_pk_bf16_f32 v38, v10, v9
    v_cos_f32 v70, v8
    v_sin_f32 v94, v8
    v_fmamk_f32 v8, v48, 0x41300000, v49
    v_cos_f32 v9, v8
    v_sin_f32 v10, v8
    v_mul_f32 v8, 0x3d000000, v8
    v_cvt_pk_bf16_f32 v23, v9, -v10
    v_cvt_pk_bf16_f32 v39, v10, v9
    v_cos_f32 v71, v8
    v_sin_f32 v95, v8
    v_fmamk_f32 v8, v48, 0x41800000, v49
    v_cos_f32 v9, v8
    v_sin_f32 v10, v8
    v_mul_f32 v8, 0x3d000000, v8
    v_cvt_pk_bf16_f32 v24, v9, -v10
    v_cvt_pk_bf16_f32 v40, v10, v9
    v_cos_f32 v112, v8
    v_sin_f32 v120, v8
    v_fmamk_f32 v8, v48, 0x41880000, v49
    v_cos_f32 v9, v8
    v_sin_f32 v10, v8
    v_mul_f32 v8, 0x3d000000, v8
    v_cvt_pk_bf16_f32 v25, v9, -v10
    v_cvt_pk_bf16_f32 v41, v10, v9
    v_cos_f32 v113, v8
    v_sin_f32 v121, v8
    v_fmamk_f32 v8, v48, 0x41900000, v49
    v_cos_f32 v9, v8
    v_sin_f32 v10, v8
    v_mul_f32 v8, 0x3d000000, v8
    v_cvt_pk_bf16_f32 v26, v9, -v10
    v_cvt_pk_bf16_f32 v42, v10, v9
    v_cos_f32 v114, v8
    v_sin_f32 v122, v8
    v_fmamk_f32 v8, v48, 0x41980000, v49
    v_cos_f32 v9, v8
    v_sin_f32 v10, v8
    v_mul_f32 v8, 0x3d000000, v8
    v_cvt_pk_bf16_f32 v27, v9, -v10
    v_cvt_pk_bf16_f32 v43, v10, v9
    v_cos_f32 v115, v8
    v_sin_f32 v123, v8
    v_fmamk_f32 v8, v48, 0x41c00000, v49
    v_cos_f32 v9, v8
    v_sin_f32 v10, v8
    v_mul_f32 v8, 0x3d000000, v8
    v_cvt_pk_bf16_f32 v28, v9, -v10
    v_cvt_pk_bf16_f32 v44, v10, v9
    v_cos_f32 v116, v8
    v_sin_f32 v124, v8
    v_fmamk_f32 v8, v48, 0x41c80000, v49
    v_cos_f32 v9, v8
    v_sin_f32 v10, v8
    v_mul_f32 v8, 0x3d000000, v8
    v_cvt_pk_bf16_f32 v29, v9, -v10
    v_cvt_pk_bf16_f32 v45, v10, v9
    v_cos_f32 v117, v8
    v_sin_f32 v125, v8
    v_fmamk_f32 v8, v48, 0x41d00000, v49
    v_cos_f32 v9, v8
    v_sin_f32 v10, v8
    v_mul_f32 v8, 0x3d000000, v8
    v_cvt_pk_bf16_f32 v30, v9, -v10
    v_cvt_pk_bf16_f32 v46, v10, v9
    v_cos_f32 v118, v8
    v_sin_f32 v126, v8
    v_fmamk_f32 v8, v48, 0x41d80000, v49
    v_cos_f32 v9, v8
    v_sin_f32 v10, v8
    v_mul_f32 v8, 0x3d000000, v8
    v_cvt_pk_bf16_f32 v31, v9, -v10
    v_cvt_pk_bf16_f32 v47, v10, v9
    v_cos_f32 v119, v8
    v_sin_f32 v127, v8
L_p3b:
    s_barrier
    s_mov_b32 s58, 0
    s_mov_b32 exec_hi, 0
L_poll2:
    buffer_load_dword v8, v7, s[16:19], s11 offen sc1
    s_add_u32 s58, s58, 1
    s_waitcnt vmcnt(0)
    v_cmp_ne_u32 vcc, s49, v8
    s_cmp_gt_u32 s58, 400000
    s_cbranch_scc1 L_poll2_d
    s_and_b64 exec, exec, vcc
    s_cbranch_execz L_poll2_d
    s_branch L_poll2
L_poll2_d:
    s_mov_b64 exec, -1
    buffer_load_dword v72, v1, s[16:19], s8 offen offset:0 sc1
    buffer_load_dword v73, v1, s[16:19], s10 offen offset:0 sc1
    buffer_load_dword v74, v1, s[16:19], s8 offen offset:2048 sc1
    buffer_load_dword v75, v1, s[16:19], s10 offen offset:2048 sc1
    buffer_load_dword v76, v1, s[16:19], s8 offen offset:512 sc1
    buffer_load_dword v77, v1, s[16:19], s10 offen offset:512 sc1
    buffer_load_dword v78, v1, s[16:19], s8 offen offset:2560 sc1
    buffer_load_dword v79, v1, s[16:19], s10 offen offset:2560 sc1
    buffer_load_dword v80, v1, s[16:19], s8 offen offset:1024 sc1
    buffer_load_dword v81, v1, s[16:19], s10 offen offset:1024 sc1
    buffer_load_dword v82, v1, s[16:19], s8 offen offset:3072 sc1
    buffer_load_dword v83, v1, s[16:19], s10 offen offset:3072 sc1
    buffer_load_dword v84, v1, s[16:19], s8 offen offset:1536 sc1
    buffer_load_dword v85, v1, s[16:19], s10 offen offset:1536 sc1
    buffer_load_dword v86, v1, s[16:19], s8 offen offset:3584 sc1
    buffer_load_dword v87, v1, s[16:19], s10 offen offset:3584 sc1
    s_waitcnt vmcnt(12)
    v_mfma_f32_16x16x32_bf16 v[96:99], v[56:59], v[72:75], 0
    v_mfma_f32_16x16x32_bf16 v[52:55], v[16:19], v[72:75], 0
    s_waitcnt vmcnt(8)
    v_mfma_f32_16x16x32_bf16 v[100:103], v[56:59], v[76:79], 0
    s_mov_b32 exec_lo, s24
    s_mov_b32 exec_hi, s24
    s_nop 3
    v_mov_b32 v96, v52
    v_mov_b32 v97, v53
    v_mov_b32 v98, v54
    v_mov_b32 v99, v55
    s_mov_b64 exec, -1
    v_cvt_pk_bf16_f32 v96, v96, v97
    v_cvt_pk_bf16_f32 v97, v98, v99
    ds_write_b32 v60, v96
    ds_write_b32 v61, v97
    s_waitcnt vmcnt(4)
    v_mfma_f32_16x16x32_bf16 v[104:107], v[56:59], v[80:83], 0
    v_cvt_pk_bf16_f32 v100, v100, v101
    v_cvt_pk_bf16_f32 v101, v102, v103
    v_xor_b32 v9, 16, v60
    ds_write_b32 v9, v100
    ds_write_b32 v62, v101
    s_waitcnt vmcnt(0)
    v_mfma_f32_16x16x32_bf16 v[108:111], v[56:59], v[84:87], 0
    s_nop 0
    v_cvt_pk_bf16_f32 v104, v104, v105
    v_cvt_pk_bf16_f32 v105, v106, v107
    v_xor_b32 v10, 32, v60
    ds_write_b32 v10, v104
    ds_write_b32 v63, v105
    s_nop 1
    v_cvt_pk_bf16_f32 v108, v108, v109
    v_cvt_pk_bf16_f32 v109, v110, v111
    v_xor_b32 v11, 48, v60
    ds_write_b32 v11, v108
    ds_write_b32 v15, v109
    v_bfe_u32 v12, v3, 1, 3
    v_xor_b32 v12, v12, v4
    v_lshlrev_b32 v12, 4, v12
    v_lshl_or_b32 v12, v3, 7, v12
    s_lshl_b32 s26, s51, 12
    s_waitcnt lgkmcnt(0)
    v_add_u32 v8, s26, v12
    v_xor_b32 v9, 32, v8
    v_xor_b32 v10, 64, v8
    v_xor_b32 v11, 96, v8
    v_lshlrev_b32 v12, 4, v4
    v_lshl_or_b32 v1, v3, 6, v12
    s_mov_b32 s12, s94
    s_mov_b32 s13, s95
    s_mov_b32 s14, 0x00400000
    s_mov_b32 s15, 0x00020000
    s_add_u32 s30, s22, 0x80000
    s_barrier
    s_cmp_ge_u32 s3, 4
    s_cbranch_scc1 L_hx
    ds_read_b128 v[48:51], v8
    ds_read_b128 v[52:55], v9
    ds_read_b128 v[56:59], v10
    ds_read_b128 v[60:63], v11
    s_waitcnt lgkmcnt(3)
    v_mfma_f32_32x32x16_bf16 v[72:87], v[48:51], v[16:19], 0
    v_mfma_f32_32x32x16_bf16 v[96:111], v[48:51], v[32:35], 0
    s_waitcnt lgkmcnt(2)
    v_mfma_f32_32x32x16_bf16 v[72:87], v[52:55], v[20:23], v[72:87]
    v_mfma_f32_32x32x16_bf16 v[96:111], v[52:55], v[36:39], v[96:111]
    s_waitcnt lgkmcnt(1)
    v_mfma_f32_32x32x16_bf16 v[72:87], v[56:59], v[24:27], v[72:87]
    v_mfma_f32_32x32x16_bf16 v[96:111], v[56:59], v[40:43], v[96:111]
    s_waitcnt lgkmcnt(0)
    v_mfma_f32_32x32x16_bf16 v[72:87], v[60:63], v[28:31], v[72:87]
    v_mfma_f32_32x32x16_bf16 v[96:111], v[60:63], v[44:47], v[96:111]
    v_bfe_u32 v10, v3, 1, 2
    v_lshlrev_b32 v10, 4, v10
    v_lshl_or_b32 v10, v3, 6, v10
    v_lshl_or_b32 v10, v4, 3, v10
    v_add_u32 v14, s26, v10
    v_xor_b32 v15, 16, v14
    v_xor_b32 v2, 32, v14
    v_xor_b32 v7, 48, v14
    v_lshlrev_b32 v6, 4, v0
    v_bfe_u32 v10, v0, 3, 2
    v_lshlrev_b32 v10, 4, v10
    v_xor_b32 v5, v6, v10
    v_add_u32 v5, s26, v5
    v_mul_f32 v8, v72, v64
    v_mul_f32 v9, v96, v64
    v_fma_f32 v8, -v96, v88, v8
    v_fmac_f32 v9, v72, v88
    v_cvt_pk_bf16_f32 v48, v8, v9
    v_mul_f32 v8, v73, v65
    v_mul_f32 v9, v97, v65
    v_fma_f32 v8, -v97, v89, v8
    v_fmac_f32 v9, v73, v89
    v_cvt_pk_bf16_f32 v49, v8, v9
    v_mul_f32 v8, v74, v66
    v_mul_f32 v9, v98, v66
    v_fma_f32 v8, -v98, v90, v8
    v_fmac_f32 v9, v74, v90
    v_cvt_pk_bf16_f32 v50, v8, v9
    v_mul_f32 v8, v75, v67
    v_mul_f32 v9, v99, v67
    v_fma_f32 v8, -v99, v91, v8
    v_fmac_f32 v9, v75, v91
    v_cvt_pk_bf16_f32 v51, v8, v9
    v_mul_f32 v8, v76, v68
    v_mul_f32 v9, v100, v68
    v_fma_f32 v8, -v100, v92, v8
    v_fmac_f32 v9, v76, v92
    v_cvt_pk_bf16_f32 v52, v8, v9
    v_mul_f32 v8, v77, v69
    v_mul_f32 v9, v101, v69
    v_fma_f32 v8, -v101, v93, v8
    v_fmac_f32 v9, v77, v93
    v_cvt_pk_bf16_f32 v53, v8, v9
    v_mul_f32 v8, v78, v70
    v_mul_f32 v9, v102, v70
    v_fma_f32 v8, -v102, v94, v8
    v_fmac_f32 v9, v78, v94
    v_cvt_pk_bf16_f32 v54, v8, v9
    v_mul_f32 v8, v79, v71
    v_mul_f32 v9, v103, v71
    v_fma_f32 v8, -v103, v95, v8
    v_fmac_f32 v9, v79, v95
    v_cvt_pk_bf16_f32 v55, v8, v9
    v_mfma_f32_32x32x16_bf16 v[64:79], v[48:51], v[16:19], 0
    v_mul_f32 v8, v80, v112
    v_mul_f32 v9, v104, v112
    v_fma_f32 v8, -v104, v120, v8
    v_fmac_f32 v9, v80, v120
    v_cvt_pk_bf16_f32 v56, v8, v9
    v_mfma_f32_32x32x16_bf16 v[88:103], v[48:51], v[32:35], 0
    v_mul_f32 v8, v81, v113
    v_mul_f32 v9, v105, v113
    v_fma_f32 v8, -v105, v121, v8
    v_fmac_f32 v9, v81, v121
    v_cvt_pk_bf16_f32 v57, v8, v9
    v_mfma_f32_32x32x16_bf16 v[64:79], v[52:55], v[20:23], v[64:79]
    v_mul_f32 v8, v82, v114
    v_mul_f32 v9, v106, v114
    v_fma_f32 v8, -v106, v122, v8
    v_fmac_f32 v9, v82, v122
    v_cvt_pk_bf16_f32 v58, v8, v9
    v_mfma_f32_32x32x16_bf16 v[88:103], v[52:55], v[36:39], v[88:103]
    v_mul_f32 v8, v83, v115
    v_mul_f32 v9, v107, v115
    v_fma_f32 v8, -v107, v123, v8
    v_fmac_f32 v9, v83, v123
    v_cvt_pk_bf16_f32 v59, v8, v9
    v_mul_f32 v8, v84, v116
    v_mul_f32 v9, v108, v116
    v_fma_f32 v8, -v108, v124, v8
    v_fmac_f32 v9, v84, v124
    v_cvt_pk_bf16_f32 v60, v8, v9
    v_mfma_f32_32x32x16_bf16 v[64:79], v[56:59], v[24:27], v[64:79]
    v_mul_f32 v8, v85, v117
    v_mul_f32 v9, v109, v117
    v_fma_f32 v8, -v109, v125, v8
    v_fmac_f32 v9, v85, v125
    v_cvt_pk_bf16_f32 v61, v8, v9
    v_mul_f32 v8, v86, v118
    v_mul_f32 v9, v110, v118
    v_fma_f32 v8, -v110, v126, v8
    v_fmac_f32 v9, v86, v126
    v_cvt_pk_bf16_f32 v62, v8, v9
    v_mfma_f32_32x32x16_bf16 v[88:103], v[56:59], v[40:43], v[88:103]
    v_mul_f32 v8, v87, v119
    v_mul_f32 v9, v111, v119
    v_fma_f32 v8, -v111, v127, v8
    v_fmac_f32 v9, v87, v127
    v_cvt_pk_bf16_f32 v63, v8, v9
    s_nop 1
    v_mfma_f32_32x32x16_bf16 v[64:79], v[60:63], v[28:31], v[64:79]
    v_mfma_f32_32x32x16_bf16 v[88:103], v[60:63], v[44:47], v[88:103]
    s_nop 10
    v_cvt_pk_bf16_f32 v16, v64, v65
    v_cvt_pk_bf16_f32 v17, v66, v67
    ds_write_b64 v14, v[16:17] offset:0
    v_cvt_pk_bf16_f32 v18, v68, v69
    v_cvt_pk_bf16_f32 v19, v70, v71
    ds_write_b64 v15, v[18:19] offset:0
    v_cvt_pk_bf16_f32 v20, v72, v73
    v_cvt_pk_bf16_f32 v21, v74, v75
    ds_write_b64 v2, v[20:21] offset:0
    v_cvt_pk_bf16_f32 v22, v76, v77
    v_cvt_pk_bf16_f32 v23, v78, v79
    ds_write_b64 v7, v[22:23] offset:0
    v_cvt_pk_bf16_f32 v24, v88, v89
    v_cvt_pk_bf16_f32 v25, v90, v91
    ds_write_b64 v14, v[24:25] offset:2048
    v_cvt_pk_bf16_f32 v26, v92, v93
    v_cvt_pk_bf16_f32 v27, v94, v95
    ds_write_b64 v15, v[26:27] offset:2048
    v_cvt_pk_bf16_f32 v28, v96, v97
    v_cvt_pk_bf16_f32 v29, v98, v99
    ds_write_b64 v2, v[28:29] offset:2048
    v_cvt_pk_bf16_f32 v30, v100, v101
    v_cvt_pk_bf16_f32 v31, v102, v103
    ds_write_b64 v7, v[30:31] offset:2048
    s_waitcnt lgkmcnt(0)
    ds_read_b128 v[32:35], v5 offset:0
    ds_read_b128 v[36:39], v5 offset:1024
    ds_read_b128 v[40:43], v5 offset:2048
    ds_read_b128 v[44:47], v5 offset:3072
    s_waitcnt lgkmcnt(3)
    buffer_store_dwordx4 v[32:35], v6, s[12:15], s22 offen offset:0 sc1
    s_waitcnt lgkmcnt(2)
    buffer_store_dwordx4 v[36:39], v6, s[12:15], s22 offen offset:1024 sc1
    s_waitcnt lgkmcnt(1)
    buffer_store_dwordx4 v[40:43], v6, s[12:15], s30 offen offset:0 sc1
    s_waitcnt lgkmcnt(0)
    buffer_store_dwordx4 v[44:47], v6, s[12:15], s30 offen offset:1024 sc1
L_fin:
L_end:
    s_endpgm
L_hx:
    s_lshl_b32 s26, s2, 3
    s_add_u32 s26, s26, s3
    s_cmp_lg_u32 s26, 4
    s_cbranch_scc1 L_fin
    s_mov_b32 s26, 0x00ef0000
    v_mov_b32 v8, s49
    v_lshlrev_b32 v9, 2, v0
    s_waitcnt vmcnt(0)
    s_mov_b32 exec_hi, 0
    buffer_store_dword v8, v9, s[16:19], s26 offen sc1
    s_mov_b32 exec_hi, -1
    s_branch L_fin
L_m0:
    v_and_b32 v8, 1, v0
    v_cmp_eq_u32 vcc, 1, v8
    v_bfe_u32 v9, v0, 2, 2
    v_lshl_or_b32 v9, v9, 1, v8
    v_cndmask_b32 v32, v96, v98, vcc
    v_cndmask_b32 v33, v97, v99, vcc
    v_lshlrev_b32 v9, 8, v9
    v_add_u32 v9, s2, v9
    v_cvt_f32_u32 v35, v9
    v_mul_f32 v35, 0x3a000000, v35
    v_cvt_f32_u32 v34, v5
    v_add_f32 v34, v34, v34
    v_mul_f32 v34, v34, v35
    v_bfe_u32 v10, v0, 1, 1
    v_lshrrev_b32 v11, 1, v5
    v_cmp_eq_u32 s[4:5], v10, v11
    v_and_b32 v11, 1, v5
    v_cmp_eq_u32 s[6:7], 0, v11
    v_cmp_eq_u32 s[28:29], 0, v10
    v_cndmask_b32 v40, 0, v32, s[4:5]
    v_cndmask_b32 v41, 0, v33, s[4:5]
    v_mul_f32 v42, 0x3e800000, v32
    v_mul_f32 v43, 0x3e800000, v33
    v_cos_f32 v36, v34
    v_sin_f32 v37, v34
    v_cndmask_b32 v38, 0, v42, s[28:29]
    v_cndmask_b32 v39, 0, v43, s[28:29]
    v_cndmask_b32 v38, v40, v38, s[6:7]
    v_cndmask_b32 v39, 0, v39, s[6:7]
    v_mul_f32 v8, v38, v36
    v_fmac_f32 v8, v39, v37
    v_mul_f32 v9, v39, v36
    v_fma_f32 v9, -v38, v37, v9
    v_cvt_pk_bf16_f32 v16, v8, v9
    v_cndmask_b32 v38, v42, 0, s[28:29]
    v_cndmask_b32 v39, v43, 0, s[28:29]
    v_cndmask_b32 v38, v41, v38, s[6:7]
    v_cndmask_b32 v39, 0, v39, s[6:7]
    v_mul_f32 v8, v38, v36
    v_fmac_f32 v8, v39, v37
    v_mul_f32 v9, v39, v36
    v_fma_f32 v9, -v38, v37, v9
    v_cvt_pk_bf16_f32 v17, v8, v9
    v_add_f32 v34, v34, v35
    v_cos_f32 v36, v34
    v_sin_f32 v37, v34
    v_mul_f32 v8, v40, v36
    v_mul_f32 v9, v40, v37
    v_cvt_pk_bf16_f32 v18, v8, -v9
    v_mul_f32 v8, v41, v36
    v_mul_f32 v9, v41, v37
    v_cvt_pk_bf16_f32 v19, v8, -v9
    s_branch L_p3b
L_el:
    v_lshlrev_b32 v2, 6, v5
    v_add_u32 v2, s25, v2
    s_mov_b32 exec_lo, s52
    s_mov_b32 exec_hi, s52
    s_waitcnt vmcnt(1)
    ds_read_b64 v[40:41], v2 offset:8
    ds_read_b64 v[42:43], v2 offset:24
    ds_read_b64 v[44:45], v2 offset:40
    ds_read_b64 v[46:47], v2 offset:56
    ds_read_b64 v[56:57], v2 offset:264
    ds_read_b64 v[58:59], v2 offset:280
    ds_read_b64 v[60:61], v2 offset:296
    ds_read_b64 v[62:63], v2 offset:312
    ds_read_b64 v[32:33], v2 offset:0
    ds_read_b64 v[34:35], v2 offset:16
    ds_read_b64 v[36:37], v2 offset:32
    ds_read_b64 v[38:39], v2 offset:48
    ds_read_b64 v[48:49], v2 offset:256
    ds_read_b64 v[50:51], v2 offset:272
    ds_read_b64 v[52:53], v2 offset:288
    ds_read_b64 v[54:55], v2 offset:304
    s_mov_b64 exec, -1
    s_and_b32 s29, s2, 0xfb
    s_cmp_eq_u32 s29, 0
    s_cbranch_scc1 L_sp
    s_waitcnt lgkmcnt(0)
    s_branch L_elb
L_sp:
    s_lshr_b32 s29, s2, 2
    s_lshl_b32 s10, s3, 1
    s_add_u32 s29, s29, s10
    s_sub_u32 s29, 16, s29
    s_sub_u32 s10, s29, 0
    s_and_b32 s10, s10, 15
    s_lshr_b32 s11, s10, 1
    s_lshl_b32 s11, s11, 8
    s_and_b32 s10, s10, 1
    s_lshl_b32 s10, s10, 3
    s_add_u32 s10, s10, s11
    v_lshlrev_b32 v27, 12, v5
    v_add_u32 v27, s10, v27
    s_sub_u32 s10, s29, 1
    s_and_b32 s10, s10, 15
    s_lshr_b32 s11, s10, 1
    s_lshl_b32 s11, s11, 8
    s_and_b32 s10, s10, 1
    s_lshl_b32 s10, s10, 3
    s_add_u32 s10, s10, s11
    v_lshlrev_b32 v28, 12, v5
    v_add_u32 v28, s10, v28
    v_mov_b32 v64, 0
    v_mov_b32 v65, 0
    v_mov_b32 v66, 0
    v_mov_b32 v67, 0
    v_mov_b32 v68, 0
    v_mov_b32 v69, 0
    v_mov_b32 v70, 0
    v_mov_b32 v71, 0
    s_mov_b32 exec_lo, 0x00010001
    s_mov_b32 exec_hi, 0x00010001
    ds_read_b64 v[64:65], v27 offset:0
    ds_read_b64 v[66:67], v27 offset:2048
    ds_read_b64 v[68:69], v28 offset:0
    ds_read_b64 v[70:71], v28 offset:2048
    s_mov_b32 s10, 0x00008000
    s_mov_b32 s11, 0x80008000
    s_waitcnt lgkmcnt(0)
    v_xor_b32 v64, s10, v64
    v_xor_b32 v65, s10, v65
    v_xor_b32 v66, s10, v66
    v_xor_b32 v67, s10, v67
    v_xor_b32 v68, s10, v68
    v_xor_b32 v69, s10, v69
    v_xor_b32 v70, s10, v70
    v_xor_b32 v71, s10, v71
    s_mov_b64 exec, -1
    s_cmp_lg_u32 s2, 0
    s_cbranch_scc1 L_sp4
    v_mfma_f32_16x16x32_bf16 v[112:115], v[80:83], v[64:67], v[112:115]
    v_mfma_f32_16x16x32_bf16 v[116:119], v[84:87], v[64:67], v[116:119]
    v_mfma_f32_16x16x32_bf16 v[120:123], v[88:91], v[68:71], v[120:123]
    v_mfma_f32_16x16x32_bf16 v[124:127], v[92:95], v[68:71], v[124:127]
    s_mov_b32 exec_lo, 0x00010001
    s_mov_b32 exec_hi, 0x00010001
    v_xor_b32 v64, s11, v64
    v_xor_b32 v65, s11, v65
    v_xor_b32 v66, s11, v66
    v_xor_b32 v67, s11, v67
    v_xor_b32 v68, s11, v68
    v_xor_b32 v69, s11, v69
    v_xor_b32 v70, s11, v70
    v_xor_b32 v71, s11, v71
    s_mov_b64 exec, -1
    v_mul_f32 v27, v112, v40
    v_mul_f32 v28, v116, v40
    v_fma_f32 v27, -v116, v41, v27
    v_fmac_f32 v28, v112, v41
    v_cvt_pk_bf16_f32 v16, v28, v27
    v_mul_f32 v26, v113, v42
    v_mul_f32 v25, v117, v42
    v_fma_f32 v26, -v117, v43, v26
    v_fmac_f32 v25, v113, v43
    v_cvt_pk_bf16_f32 v17, v25, v26
    v_mul_f32 v27, v114, v44
    v_mul_f32 v28, v118, v44
    v_fma_f32 v27, -v118, v45, v27
    v_fmac_f32 v28, v114, v45
    v_cvt_pk_bf16_f32 v18, v28, v27
    v_mul_f32 v26, v115, v46
    v_mul_f32 v25, v119, v46
    v_fma_f32 v26, -v119, v47, v26
    v_fmac_f32 v25, v115, v47
    v_cvt_pk_bf16_f32 v19, v25, v26
    s_nop 1
    v_mfma_f32_16x16x32_bf16 v[40:43], v[96:99], v[16:19], 0
    v_mfma_f32_16x16x32_bf16 v[44:47], v[100:103], v[16:19], 0
    v_mfma_f32_16x16x32_bf16 v[112:115], v[80:83], v[64:67], v[112:115]
    v_mfma_f32_16x16x32_bf16 v[116:119], v[84:87], v[64:67], v[116:119]
    v_mfma_f32_16x16x32_bf16 v[112:115], v[80:83], v[64:67], v[112:115]
    v_mfma_f32_16x16x32_bf16 v[116:119], v[84:87], v[64:67], v[116:119]
    v_mul_f32 v27, v120, v56
    v_mul_f32 v28, v124, v56
    v_fma_f32 v27, -v124, v57, v27
    v_fmac_f32 v28, v120, v57
    v_cvt_pk_bf16_f32 v20, v28, v27
    v_mul_f32 v26, v121, v58
    v_mul_f32 v25, v125, v58
    v_fma_f32 v26, -v125, v59, v26
    v_fmac_f32 v25, v121, v59
    v_cvt_pk_bf16_f32 v21, v25, v26
    v_mul_f32 v27, v122, v60
    v_mul_f32 v28, v126, v60
    v_fma_f32 v27, -v126, v61, v27
    v_fmac_f32 v28, v122, v61
    v_cvt_pk_bf16_f32 v22, v28, v27
    v_mul_f32 v26, v123, v62
    v_mul_f32 v25, v127, v62
    v_fma_f32 v26, -v127, v63, v26
    v_fmac_f32 v25, v123, v63
    v_cvt_pk_bf16_f32 v23, v25, v26
    s_nop 1
    v_mfma_f32_16x16x32_bf16 v[56:59], v[104:107], v[20:23], 0
    v_mfma_f32_16x16x32_bf16 v[60:63], v[108:111], v[20:23], 0
    v_mfma_f32_16x16x32_bf16 v[120:123], v[88:91], v[68:71], v[120:123]
    v_mfma_f32_16x16x32_bf16 v[124:127], v[92:95], v[68:71], v[124:127]
    v_mfma_f32_16x16x32_bf16 v[120:123], v[88:91], v[68:71], v[120:123]
    v_mfma_f32_16x16x32_bf16 v[124:127], v[92:95], v[68:71], v[124:127]
    v_cvt_pk_bf16_f32 v16, v40, v44
    v_cvt_pk_bf16_f32 v18, v41, v45
    s_nop 1
    v_cvt_pk_bf16_f32 v17, v56, v60
    v_cvt_pk_bf16_f32 v19, v57, v61
    ds_write_b128 v30, v[16:19] offset:3072
    v_cvt_pk_bf16_f32 v20, v42, v46
    v_cvt_pk_bf16_f32 v22, v43, v47
    v_cvt_pk_bf16_f32 v21, v58, v62
    v_cvt_pk_bf16_f32 v23, v59, v63
    ds_write_b128 v30, v[20:23] offset:3328
    s_waitcnt lgkmcnt(0)
    s_barrier
    s_nop 7
    s_branch L_spb
L_sp4:
    s_nop 1
    v_mfma_f32_16x16x32_bf16 v[112:115], v[88:91], v[64:67], v[112:115]
    v_mfma_f32_16x16x32_bf16 v[116:119], v[92:95], v[64:67], v[116:119]
    v_mfma_f32_16x16x32_bf16 v[120:123], v[8:11], v[68:71], v[120:123]
    v_mfma_f32_16x16x32_bf16 v[124:127], v[12:15], v[68:71], v[124:127]
    s_mov_b32 exec_lo, 0x00010001
    s_mov_b32 exec_hi, 0x00010001
    v_xor_b32 v64, s11, v64
    v_xor_b32 v65, s11, v65
    v_xor_b32 v66, s11, v66
    v_xor_b32 v67, s11, v67
    v_xor_b32 v68, s11, v68
    v_xor_b32 v69, s11, v69
    v_xor_b32 v70, s11, v70
    v_xor_b32 v71, s11, v71
    s_mov_b64 exec, -1
    v_mul_f32 v27, v112, v40
    v_mul_f32 v28, v116, v40
    v_fma_f32 v27, -v116, v41, v27
    v_fmac_f32 v28, v112, v41
    v_cvt_pk_bf16_f32 v16, v28, v27
    v_mul_f32 v26, v113, v42
    v_mul_f32 v25, v117, v42
    v_fma_f32 v26, -v117, v43, v26
    v_fmac_f32 v25, v113, v43
    v_cvt_pk_bf16_f32 v17, v25, v26
    v_mul_f32 v27, v114, v44
    v_mul_f32 v28, v118, v44
    v_fma_f32 v27, -v118, v45, v27
    v_fmac_f32 v28, v114, v45
    v_cvt_pk_bf16_f32 v18, v28, v27
    v_mul_f32 v26, v115, v46
    v_mul_f32 v25, v119, v46
    v_fma_f32 v26, -v119, v47, v26
    v_fmac_f32 v25, v115, v47
    v_cvt_pk_bf16_f32 v19, v25, v26
    s_nop 1
    v_mfma_f32_16x16x32_bf16 v[40:43], v[96:99], v[16:19], 0
    v_mfma_f32_16x16x32_bf16 v[44:47], v[100:103], v[16:19], 0
    v_mfma_f32_16x16x32_bf16 v[112:115], v[88:91], v[64:67], v[112:115]
    v_mfma_f32_16x16x32_bf16 v[116:119], v[92:95], v[64:67], v[116:119]
    v_mfma_f32_16x16x32_bf16 v[112:115], v[88:91], v[64:67], v[112:115]
    v_mfma_f32_16x16x32_bf16 v[116:119], v[92:95], v[64:67], v[116:119]
    v_mul_f32 v27, v120, v56
    v_mul_f32 v28, v124, v56
    v_fma_f32 v27, -v124, v57, v27
    v_fmac_f32 v28, v120, v57
    v_cvt_pk_bf16_f32 v20, v28, v27
    v_mul_f32 v26, v121, v58
    v_mul_f32 v25, v125, v58
    v_fma_f32 v26, -v125, v59, v26
    v_fmac_f32 v25, v121, v59
    v_cvt_pk_bf16_f32 v21, v25, v26
    v_mul_f32 v27, v122, v60
    v_mul_f32 v28, v126, v60
    v_fma_f32 v27, -v126, v61, v27
    v_fmac_f32 v28, v122, v61
    v_cvt_pk_bf16_f32 v22, v28, v27
    v_mul_f32 v26, v123, v62
    v_mul_f32 v25, v127, v62
    v_fma_f32 v26, -v127, v63, v26
    v_fmac_f32 v25, v123, v63
    v_cvt_pk_bf16_f32 v23, v25, v26
    s_nop 1
    v_mfma_f32_16x16x32_bf16 v[56:59], v[104:107], v[20:23], 0
    v_mfma_f32_16x16x32_bf16 v[60:63], v[108:111], v[20:23], 0
    v_mfma_f32_16x16x32_bf16 v[120:123], v[8:11], v[68:71], v[120:123]
    v_mfma_f32_16x16x32_bf16 v[124:127], v[12:15], v[68:71], v[124:127]
    v_mfma_f32_16x16x32_bf16 v[120:123], v[8:11], v[68:71], v[120:123]
    v_mfma_f32_16x16x32_bf16 v[124:127], v[12:15], v[68:71], v[124:127]
    v_cvt_pk_bf16_f32 v16, v40, v44
    v_cvt_pk_bf16_f32 v18, v41, v45
    s_nop 1
    v_cvt_pk_bf16_f32 v17, v56, v60
    v_cvt_pk_bf16_f32 v19, v57, v61
    ds_write_b128 v30, v[16:19] offset:3072
    v_cvt_pk_bf16_f32 v20, v42, v46
    v_cvt_pk_bf16_f32 v22, v43, v47
    v_cvt_pk_bf16_f32 v21, v58, v62
    v_cvt_pk_bf16_f32 v23, v59, v63
    ds_write_b128 v30, v[20:23] offset:3328
    s_waitcnt lgkmcnt(0)
    s_barrier
    s_nop 7
    s_branch L_spb
.rept 96
    s_endpgm
.endr
L_code_end:
.section .rodata,"a"
.p2align 6
.amdhsa_kernel gated_mix__spectral_gfnet__spectral_gfnet__prompt_kernel
  .amdhsa_next_free_vgpr 128
  .amdhsa_next_free_sgpr 96
  .amdhsa_accum_offset 128
  .amdhsa_group_segment_fixed_size 0
  .amdhsa_kernarg_size 80
  .amdhsa_user_sgpr_count 2
  .amdhsa_user_sgpr_kernarg_segment_ptr 1
  .amdhsa_system_sgpr_workgroup_id_x 1
  .amdhsa_float_denorm_mode_32 3
.end_amdhsa_kernel
```
